```python
import torch

def _softmax(x, axis=-1):
    return torch.softmax(x, dim=axis)
def _gelu(x):
    return torch.nn.functional.gelu(x, approximate="tanh")
def _silu(x):
    return torch.nn.functional.silu(x)
def _sigmoid(x):
    return torch.sigmoid(x)
def _layernorm(x, axis=-1, eps=1e-5):
    m = x.mean(dim=axis, keepdim=True)
    v = x.var(dim=axis, keepdim=True, unbiased=False)
    return (x - m) / torch.sqrt(v + eps)
def _scatter_add(tgt, idx, src, axis=0):
    return tgt.clone().index_add_(axis, idx, src)
def _segment_sum(src, seg, n):
    out = torch.zeros((n,) + src.shape[1:], dtype=src.dtype)
    return out.index_add_(0, seg, src)
def _pad(x, pw):
    flat = tuple(v for pair in reversed(pw) for v in pair)
    return torch.nn.functional.pad(x, flat)

kernel_name = 'recurrent_scan__gqa_block_cached__dense_activation_relu__decode'

def setup_inputs():

    _w = (lambda a: (lambda t: t.to(torch.bfloat16) if t.is_floating_point() else t)(torch.as_tensor(a)))
    def _A_setup():
        B, Sq, D = 1, 1, 512
        Hq, Hkv, Sk, Dh = 32, 32, 32768, 128
        assert Hq % Hkv == 0, (Hq, Hkv)
        return {
            "x": _w((lambda *s: torch.randn(*s, dtype=torch.bfloat16) * 0.05)(B, Sq, D)),
            "k_cache": _w((lambda *s: torch.randn(*s, dtype=torch.bfloat16) * 0.8)(B, Hkv, Sk, Dh)),
            "v_cache": _w((lambda *s: torch.randn(*s, dtype=torch.bfloat16) * 0.8)(B, Hkv, Sk, Dh)),
            "wq": _w((lambda *s: torch.randn(*s, dtype=torch.bfloat16) * 0.8)(D, Hq * Dh) * (D ** -0.5)),
            "wo": _w((lambda *s: torch.randn(*s, dtype=torch.bfloat16) * 0.8)(Hq * Dh, D) * ((Hq * Dh) ** -0.5)),
        }
    _A_in = _A_setup()

    def _B_setup():
        B, S, D, Dff = 1, 1, 512, 1376
        return {
            "x": _w((lambda *s: torch.randn(*s, dtype=torch.bfloat16) * 0.05)(B, S, D)),
            "w1": _w((lambda *s: torch.randn(*s, dtype=torch.bfloat16) * 0.2)(D, Dff)),
            "w2": _w((lambda *s: torch.randn(*s, dtype=torch.bfloat16) * 0.2)(Dff, D)),
        }
    _B_in = _B_setup()

    return {
        "A_x": _A_in["x"],
        "A_k_cache": _A_in["k_cache"],
        "A_v_cache": _A_in["v_cache"],
        "A_wq": _A_in["wq"],
        "A_wo": _A_in["wo"],
        "B_x": _B_in["x"],
        "B_w1": _B_in["w1"],
        "B_w2": _B_in["w2"],
    }

def reference(A_x, A_k_cache, A_v_cache, A_wq, A_wo, B_x, B_w1, B_w2):
    def _A_ref(x, k_cache, v_cache, wq, wo):
        B, Sq, D = x.shape
        Hq, Dh = 32, 128
        Hkv = k_cache.shape[1]
        rep = Hq // Hkv
        q = (lambda x, *d: x.permute(*d))((x @ wq).reshape(B, Sq, Hq, Dh), 0, 2, 1, 3)
        k = (lambda x, n, axis: torch.repeat_interleave(x, n, dim=axis))(k_cache, rep, axis=1)
        v = (lambda x, n, axis: torch.repeat_interleave(x, n, dim=axis))(v_cache, rep, axis=1)
        scores = torch.einsum("bhqd,bhkd->bhqk", q, k) * (Dh ** -0.5)
        p = _softmax(scores, axis=-1)
        o = torch.einsum("bhqk,bhkd->bhqd", p, v)
        return (lambda x, *d: x.permute(*d))(o, 0, 2, 1, 3).reshape(B, Sq, Hq * Dh) @ wo

    def _B_ref(x, w1, w2):
        h = torch.einsum("bsd,df->bsf", x, w1)
        zero = torch.zeros_like(h)
        h = torch.maximum(h, zero)
        return torch.einsum("bsf,fd->bsd", h, w2)

    x = A_x
    xn = _layernorm(x, axis=-1)
    s = _A_ref(xn, A_k_cache, A_v_cache, A_wq, A_wo)
    g = _silu(_B_ref(xn, B_w1, B_w2))
    return x + s * g
```

```asm
; @launch grid=(256,1,1) block=(256,1,1) lds=68096
.amdgcn_target "amdgcn-amd-amdhsa--gfx950"
.text
.globl recurrent_scan__gqa_block_cached__dense_activation_relu__decode_kernel
.p2align 8
.type recurrent_scan__gqa_block_cached__dense_activation_relu__decode_kernel,@function
recurrent_scan__gqa_block_cached__dense_activation_relu__decode_kernel:
  s_cmp_ge_u32 s2, 256
  s_cbranch_scc1 L_end
  s_load_dwordx16 s[4:19], s[0:1], 0
  s_load_dwordx4 s[20:23], s[0:1], 64
  s_load_dwordx2 s[24:25], s[0:1], 80
  s_memrealtime s[80:81]
  v_lshrrev_b32 v1, 6, v0
  v_and_b32 v0, 63, v0
  s_and_b32 s66, s2, 7
  v_readfirstlane_b32 s3, v1
  s_lshr_b32 s67, s2, 3
  s_lshr_b32 s68, s66, 0
  s_and_b32 s69, s66, 0
  s_lshr_b32 s60, s67, 3
  s_and_b32 s70, s67, 7
  s_mul_i32 s60, s60, 8
  s_add_u32 s60, s60, s68
  s_mul_i32 s61, s69, 8
  s_add_u32 s61, s61, s70
  s_lshl_b32 s74, s60, 23
  s_mov_b32 s90, s61
  s_and_b32 s90, s90, 7
  s_lshr_b32 s63, s60, 3
  v_lshrrev_b32 v14, 4, v0
  v_and_b32 v15, 15, v0
  v_lshlrev_b32 v3, 4, v0
  v_bfe_u32 v236, v0, 2, 2
  v_lshlrev_b32 v2, 8, v236
  v_lshl_add_u32 v2, v14, 6, v2
  v_and_b32 v237, 3, v0
  v_lshl_add_u32 v2, v237, 4, v2
  v_mov_b32 v1, 0
  v_mov_b32 v236, 0
  v_mov_b32 v237, 0
  v_mov_b32 v238, 84
  v_mov_b32 v239, 0
  ds_write_b128 v1, v[236:239] offset:256
  ds_write_b64 v1, v[236:237] offset:288
  ds_write_b64 v1, v[236:237] offset:296
  s_and_b32 s66, s60, 7
  s_mul_i32 s66, s66, 43
  s_add_u32 s67, s66, 43
  s_lshr_b32 s66, s66, 3
  s_lshr_b32 s67, s67, 3
  s_sub_u32 s67, s67, s66
  s_add_u32 s66, s63, 4
  s_cmp_lt_u32 s66, s67
  s_cselect_b32 s66, 6, 5
  s_cmp_lt_u32 s61, s66
  s_cselect_b32 s26, 0, 6
  s_add_u32 s26, s26, 243
  s_sub_u32 s27, s26, 1
  s_sub_u32 s67, 8, s66
  s_mul_i32 s67, s67, 6
  s_add_u32 s52, s67, 1944
  s_sub_u32 s53, 2048, s52
  s_max_u32 s65, s61, s66
  s_sub_u32 s65, s65, s66
  s_mul_i32 s65, s65, 6
  s_mul_i32 s66, s61, 3
  s_add_u32 s65, s65, s66
  s_add_u32 s65, s65, 1680
  s_lshl_b32 s65, s65, 12
  s_add_u32 s65, s65, s74
  s_lshl_b32 s66, s26, 8
  v_lshlrev_b32 v240, 2, v0
  v_add_u32 v240, s66, v240
  v_mov_b32 v241, 0xff61b1e6
  ds_write_b32 v240, v241 offset:4096
  s_cmp_eq_u32 s3, 0
  s_cbranch_scc1 L_wave0
  s_add_u32 s91, s3, -1
  s_lshr_b32 s93, s91, 3
  s_lshl_b32 s93, s93, 3
  s_add_u32 s93, s93, s90
  s_lshl_b32 s93, s93, 1
  s_lshl_b32 s94, s63, 1
  s_add_u32 s94, s91, s94
  s_and_b32 s94, s94, 7
  s_lshl_b32 s93, s93, 14
  s_lshl_b32 s94, s94, 12
  s_add_u32 s93, s93, s94
  s_add_u32 s92, s93, s74
  s_waitcnt lgkmcnt(0)
  s_mov_b32 s28, s6
  s_mov_b32 s29, s7
  s_mov_b32 s30, 268435456
  s_mov_b32 s31, 0x00020000
  s_mov_b32 s32, s8
  s_mov_b32 s33, s9
  s_mov_b32 s34, 268435456
  s_mov_b32 s35, 0x00020000
  buffer_load_dwordx4 a[0:3], v2, s[28:31], s92 offen offset:0 nt
  buffer_load_dwordx4 a[4:7], v2, s[28:31], s92 offen offset:1024 nt
  buffer_load_dwordx4 a[8:11], v2, s[28:31], s92 offen offset:2048 nt
  buffer_load_dwordx4 a[12:15], v2, s[28:31], s92 offen offset:3072 nt
  s_add_u32 s91, s3, 2
  s_lshr_b32 s93, s91, 3
  s_lshl_b32 s93, s93, 3
  s_add_u32 s93, s93, s90
  s_lshl_b32 s93, s93, 1
  s_lshl_b32 s94, s63, 1
  s_add_u32 s94, s91, s94
  s_and_b32 s94, s94, 7
  s_lshl_b32 s93, s93, 14
  s_lshl_b32 s94, s94, 12
  s_add_u32 s93, s93, s94
  s_add_u32 s92, s93, s74
  buffer_load_dwordx4 a[64:67], v2, s[28:31], s92 offen offset:0 nt
  buffer_load_dwordx4 a[68:71], v2, s[28:31], s92 offen offset:1024 nt
  buffer_load_dwordx4 a[72:75], v2, s[28:31], s92 offen offset:2048 nt
  buffer_load_dwordx4 a[76:79], v2, s[28:31], s92 offen offset:3072 nt
  s_barrier
  v_and_b32 v244, 1, v0
  v_lshlrev_b32 v244, 4, v244
  v_mov_b32 v245, 0xffff
  v_lshlrev_b32 v245, v244, v245
  v_and_b32 v246, 2, v0
  v_cmp_eq_u32 vcc, 0, v246
  v_bfe_u32 v246, v0, 1, 2
  s_nop 0
  v_cndmask_b32 v9, 0, v245, vcc
  v_cndmask_b32 v10, v245, 0, vcc
  v_cmp_eq_u32 vcc, 0, v246
  s_nop 1
  v_cndmask_b32 v20, 0, v245, vcc
  v_cmp_eq_u32 vcc, 1, v246
  s_nop 1
  v_cndmask_b32 v21, 0, v245, vcc
  v_cmp_eq_u32 vcc, 2, v246
  s_nop 1
  v_cndmask_b32 v22, 0, v245, vcc
  v_cmp_eq_u32 vcc, 3, v246
  s_nop 1
  v_cndmask_b32 v23, 0, v245, vcc
  v_mov_b32 v6, 0x3e0293ee
  v_mov_b32 v4, 0xff61b1e6
  v_mov_b32 v220, 0
  v_mov_b32 v221, 0
  v_mov_b32 v222, 0
  v_mov_b32 v223, 0
  v_mov_b32 v224, 0x3f803f80
  v_mov_b32 v225, 0x3f803f80
  v_mov_b32 v52, 0
  v_mov_b32 v53, 0
  v_mov_b32 v54, 0
  v_mov_b32 v55, 0
  v_mov_b32 v56, 0
  v_mov_b32 v57, 0
  v_mov_b32 v58, 0
  v_mov_b32 v59, 0
  v_mov_b32 v60, 0
  v_mov_b32 v61, 0
  v_mov_b32 v62, 0
  v_mov_b32 v63, 0
  v_mov_b32 v64, 0
  v_mov_b32 v65, 0
  v_mov_b32 v66, 0
  v_mov_b32 v67, 0
  v_mov_b32 v68, 0
  v_mov_b32 v69, 0
  v_mov_b32 v70, 0
  v_mov_b32 v71, 0
  v_mov_b32 v72, 0
  v_mov_b32 v73, 0
  v_mov_b32 v74, 0
  v_mov_b32 v75, 0
  v_mov_b32 v76, 0
  v_mov_b32 v77, 0
  v_mov_b32 v78, 0
  v_mov_b32 v79, 0
  v_mov_b32 v80, 0
  v_mov_b32 v81, 0
  v_mov_b32 v82, 0
  v_mov_b32 v83, 0
  v_mov_b32 v227, 1
  v_lshlrev_b32 v230, 2, v0
  v_lshlrev_b32 v11, 6, v15
  v_and_b32 v244, 1, v14
  v_lshl_add_u32 v11, v244, 5, v11
  v_lshrrev_b32 v244, 1, v14
  v_lshl_add_u32 v11, v244, 4, v11
  s_mov_b32 s56, s24
  s_mov_b32 s57, s25
  s_mov_b32 s58, 1769472
  s_mov_b32 s59, 0x00020000
  s_mov_b32 s44, s4
  s_mov_b32 s45, s5
  s_mov_b32 s46, 1024
  s_mov_b32 s47, 0x00020000
  s_mov_b32 s88, 0x7fffffff
  s_lshl_b32 s75, s60, 3
  s_add_u32 s75, s75, s61
  s_lshl_b32 s66, s60, 8
  s_add_u32 s66, s66, 983040
  s_add_u32 s86, s24, s66
  s_addc_u32 s87, s25, 0
  s_add_u32 s91, s3, 5
  s_lshr_b32 s93, s91, 3
  s_lshl_b32 s93, s93, 3
  s_add_u32 s93, s93, s90
  s_lshl_b32 s93, s93, 1
  s_lshl_b32 s94, s63, 1
  s_add_u32 s94, s91, s94
  s_and_b32 s94, s94, 7
  s_lshl_b32 s93, s93, 14
  s_lshl_b32 s94, s94, 12
  s_add_u32 s93, s93, s94
  s_add_u32 s92, s93, s74
  s_waitcnt vmcnt(6)
  buffer_load_dwordx4 a[80:83], v2, s[28:31], s92 offen offset:0 nt
  s_waitcnt vmcnt(6)
  buffer_load_dwordx4 a[84:87], v2, s[28:31], s92 offen offset:1024 nt
  s_waitcnt vmcnt(6)
  buffer_load_dwordx4 a[88:91], v2, s[28:31], s92 offen offset:2048 nt
  s_waitcnt vmcnt(6)
  buffer_load_dwordx4 a[92:95], v2, s[28:31], s92 offen offset:3072 nt
  s_add_u32 s91, s3, 8
  s_lshr_b32 s93, s91, 3
  s_lshl_b32 s93, s93, 3
  s_add_u32 s93, s93, s90
  s_lshl_b32 s93, s93, 1
  s_lshl_b32 s94, s63, 1
  s_add_u32 s94, s91, s94
  s_and_b32 s94, s94, 7
  s_lshl_b32 s93, s93, 14
  s_lshl_b32 s94, s94, 12
  s_add_u32 s93, s93, s94
  s_add_u32 s92, s93, s74
  s_waitcnt vmcnt(6)
  buffer_load_dwordx4 a[96:99], v2, s[28:31], s92 offen offset:0 nt
  s_waitcnt vmcnt(6)
  buffer_load_dwordx4 a[100:103], v2, s[28:31], s92 offen offset:1024 nt
  s_waitcnt vmcnt(6)
  buffer_load_dwordx4 a[104:107], v2, s[28:31], s92 offen offset:2048 nt
  s_waitcnt vmcnt(6)
  buffer_load_dwordx4 a[108:111], v2, s[28:31], s92 offen offset:3072 nt
  s_add_u32 s91, s3, 11
  s_lshr_b32 s93, s91, 3
  s_lshl_b32 s93, s93, 3
  s_add_u32 s93, s93, s90
  s_lshl_b32 s93, s93, 1
  s_lshl_b32 s94, s63, 1
  s_add_u32 s94, s91, s94
  s_and_b32 s94, s94, 7
  s_lshl_b32 s93, s93, 14
  s_lshl_b32 s94, s94, 12
  s_add_u32 s93, s93, s94
  s_add_u32 s92, s93, s74
  s_waitcnt vmcnt(6)
  buffer_load_dwordx4 a[16:19], v2, s[28:31], s92 offen offset:0 nt
  s_waitcnt vmcnt(6)
  buffer_load_dwordx4 a[20:23], v2, s[28:31], s92 offen offset:1024 nt
  s_waitcnt vmcnt(6)
  buffer_load_dwordx4 a[24:27], v2, s[28:31], s92 offen offset:2048 nt
  s_waitcnt vmcnt(6)
  buffer_load_dwordx4 a[28:31], v2, s[28:31], s92 offen offset:3072 nt
  s_add_u32 s91, s3, 14
  s_lshr_b32 s93, s91, 3
  s_lshl_b32 s93, s93, 3
  s_add_u32 s93, s93, s90
  s_lshl_b32 s93, s93, 1
  s_lshl_b32 s94, s63, 1
  s_add_u32 s94, s91, s94
  s_and_b32 s94, s94, 7
  s_lshl_b32 s93, s93, 14
  s_lshl_b32 s94, s94, 12
  s_add_u32 s93, s93, s94
  s_add_u32 s92, s93, s74
  s_waitcnt vmcnt(6)
  buffer_load_dwordx4 a[112:115], v2, s[28:31], s92 offen offset:0 nt
  s_waitcnt vmcnt(6)
  buffer_load_dwordx4 a[116:119], v2, s[28:31], s92 offen offset:1024 nt
  s_waitcnt vmcnt(6)
  buffer_load_dwordx4 a[120:123], v2, s[28:31], s92 offen offset:2048 nt
  s_waitcnt vmcnt(6)
  buffer_load_dwordx4 a[124:127], v2, s[28:31], s92 offen offset:3072 nt
  s_add_u32 s91, s3, 17
  s_lshr_b32 s93, s91, 3
  s_lshl_b32 s93, s93, 3
  s_add_u32 s93, s93, s90
  s_lshl_b32 s93, s93, 1
  s_lshl_b32 s94, s63, 1
  s_add_u32 s94, s91, s94
  s_and_b32 s94, s94, 7
  s_lshl_b32 s93, s93, 14
  s_lshl_b32 s94, s94, 12
  s_add_u32 s93, s93, s94
  s_add_u32 s92, s93, s74
  s_waitcnt vmcnt(6)
  buffer_load_dwordx4 a[128:131], v2, s[28:31], s92 offen offset:0 nt
  s_waitcnt vmcnt(6)
  buffer_load_dwordx4 a[132:135], v2, s[28:31], s92 offen offset:1024 nt
  s_waitcnt vmcnt(6)
  buffer_load_dwordx4 a[136:139], v2, s[28:31], s92 offen offset:2048 nt
  s_waitcnt vmcnt(6)
  buffer_load_dwordx4 a[140:143], v2, s[28:31], s92 offen offset:3072 nt
  s_add_u32 s91, s3, 20
  s_lshr_b32 s93, s91, 3
  s_lshl_b32 s93, s93, 3
  s_add_u32 s93, s93, s90
  s_lshl_b32 s93, s93, 1
  s_lshl_b32 s94, s63, 1
  s_add_u32 s94, s91, s94
  s_and_b32 s94, s94, 7
  s_lshl_b32 s93, s93, 14
  s_lshl_b32 s94, s94, 12
  s_add_u32 s93, s93, s94
  s_add_u32 s92, s93, s74
  s_waitcnt vmcnt(6)
  buffer_load_dwordx4 a[144:147], v2, s[28:31], s92 offen offset:0 nt
  s_waitcnt vmcnt(6)
  buffer_load_dwordx4 a[148:151], v2, s[28:31], s92 offen offset:1024 nt
  s_waitcnt vmcnt(6)
  buffer_load_dwordx4 a[152:155], v2, s[28:31], s92 offen offset:2048 nt
  s_waitcnt vmcnt(6)
  buffer_load_dwordx4 a[156:159], v2, s[28:31], s92 offen offset:3072 nt
  s_add_u32 s91, s3, 23
  s_lshr_b32 s93, s91, 3
  s_lshl_b32 s93, s93, 3
  s_add_u32 s93, s93, s90
  s_lshl_b32 s93, s93, 1
  s_lshl_b32 s94, s63, 1
  s_add_u32 s94, s91, s94
  s_and_b32 s94, s94, 7
  s_lshl_b32 s93, s93, 14
  s_lshl_b32 s94, s94, 12
  s_add_u32 s93, s93, s94
  s_add_u32 s92, s93, s74
  s_waitcnt vmcnt(6)
  buffer_load_dwordx4 a[160:163], v2, s[28:31], s92 offen offset:0 nt
  s_waitcnt vmcnt(6)
  buffer_load_dwordx4 a[164:167], v2, s[28:31], s92 offen offset:1024 nt
  s_waitcnt vmcnt(6)
  buffer_load_dwordx4 a[168:171], v2, s[28:31], s92 offen offset:2048 nt
  s_waitcnt vmcnt(6)
  buffer_load_dwordx4 a[172:175], v2, s[28:31], s92 offen offset:3072 nt
  s_add_u32 s91, s3, 26
  s_lshr_b32 s93, s91, 3
  s_lshl_b32 s93, s93, 3
  s_add_u32 s93, s93, s90
  s_lshl_b32 s93, s93, 1
  s_lshl_b32 s94, s63, 1
  s_add_u32 s94, s91, s94
  s_and_b32 s94, s94, 7
  s_lshl_b32 s93, s93, 14
  s_lshl_b32 s94, s94, 12
  s_add_u32 s93, s93, s94
  s_add_u32 s92, s93, s74
  s_waitcnt vmcnt(6)
  buffer_load_dwordx4 a[176:179], v2, s[28:31], s92 offen offset:0 nt
  s_waitcnt vmcnt(6)
  buffer_load_dwordx4 a[180:183], v2, s[28:31], s92 offen offset:1024 nt
  s_waitcnt vmcnt(6)
  buffer_load_dwordx4 a[184:187], v2, s[28:31], s92 offen offset:2048 nt
  s_waitcnt vmcnt(6)
  buffer_load_dwordx4 a[188:191], v2, s[28:31], s92 offen offset:3072 nt
  s_add_u32 s91, s3, 29
  s_lshr_b32 s93, s91, 3
  s_lshl_b32 s93, s93, 3
  s_add_u32 s93, s93, s90
  s_lshl_b32 s93, s93, 1
  s_lshl_b32 s94, s63, 1
  s_add_u32 s94, s91, s94
  s_and_b32 s94, s94, 7
  s_lshl_b32 s93, s93, 14
  s_lshl_b32 s94, s94, 12
  s_add_u32 s93, s93, s94
  s_add_u32 s92, s93, s74
  s_waitcnt vmcnt(6)
  buffer_load_dwordx4 a[32:35], v2, s[28:31], s92 offen offset:0 nt
  s_waitcnt vmcnt(6)
  buffer_load_dwordx4 a[36:39], v2, s[28:31], s92 offen offset:1024 nt
  s_waitcnt vmcnt(6)
  buffer_load_dwordx4 a[40:43], v2, s[28:31], s92 offen offset:2048 nt
  s_waitcnt vmcnt(6)
  buffer_load_dwordx4 a[44:47], v2, s[28:31], s92 offen offset:3072 nt
  s_add_u32 s91, s3, 32
  s_lshr_b32 s93, s91, 3
  s_lshl_b32 s93, s93, 3
  s_add_u32 s93, s93, s90
  s_lshl_b32 s93, s93, 1
  s_lshl_b32 s94, s63, 1
  s_add_u32 s94, s91, s94
  s_and_b32 s94, s94, 7
  s_lshl_b32 s93, s93, 14
  s_lshl_b32 s94, s94, 12
  s_add_u32 s93, s93, s94
  s_add_u32 s92, s93, s74
  s_waitcnt vmcnt(6)
  buffer_load_dwordx4 a[192:195], v2, s[28:31], s92 offen offset:0 nt
  s_waitcnt vmcnt(6)
  buffer_load_dwordx4 a[196:199], v2, s[28:31], s92 offen offset:1024 nt
  s_waitcnt vmcnt(6)
  buffer_load_dwordx4 a[200:203], v2, s[28:31], s92 offen offset:2048 nt
  s_waitcnt vmcnt(6)
  buffer_load_dwordx4 a[204:207], v2, s[28:31], s92 offen offset:3072 nt
  s_add_u32 s91, s3, 35
  s_lshr_b32 s93, s91, 3
  s_lshl_b32 s93, s93, 3
  s_add_u32 s93, s93, s90
  s_lshl_b32 s93, s93, 1
  s_lshl_b32 s94, s63, 1
  s_add_u32 s94, s91, s94
  s_and_b32 s94, s94, 7
  s_lshl_b32 s93, s93, 14
  s_lshl_b32 s94, s94, 12
  s_add_u32 s93, s93, s94
  s_add_u32 s92, s93, s74
  s_waitcnt vmcnt(6)
  buffer_load_dwordx4 a[208:211], v2, s[28:31], s92 offen offset:0 nt
  s_waitcnt vmcnt(6)
  buffer_load_dwordx4 a[212:215], v2, s[28:31], s92 offen offset:1024 nt
  s_waitcnt vmcnt(6)
  buffer_load_dwordx4 a[216:219], v2, s[28:31], s92 offen offset:2048 nt
  s_waitcnt vmcnt(6)
  buffer_load_dwordx4 a[220:223], v2, s[28:31], s92 offen offset:3072 nt
  s_add_u32 s91, s3, 38
  s_lshr_b32 s93, s91, 3
  s_lshl_b32 s93, s93, 3
  s_add_u32 s93, s93, s90
  s_lshl_b32 s93, s93, 1
  s_lshl_b32 s94, s63, 1
  s_add_u32 s94, s91, s94
  s_and_b32 s94, s94, 7
  s_lshl_b32 s93, s93, 14
  s_lshl_b32 s94, s94, 12
  s_add_u32 s93, s93, s94
  s_add_u32 s92, s93, s74
  s_waitcnt vmcnt(6)
  buffer_load_dwordx4 a[224:227], v2, s[28:31], s92 offen offset:0 nt
  s_waitcnt vmcnt(6)
  buffer_load_dwordx4 a[228:231], v2, s[28:31], s92 offen offset:1024 nt
  s_waitcnt vmcnt(6)
  buffer_load_dwordx4 a[232:235], v2, s[28:31], s92 offen offset:2048 nt
  s_waitcnt vmcnt(6)
  buffer_load_dwordx4 a[236:239], v2, s[28:31], s92 offen offset:3072 nt
  s_add_u32 s91, s3, 41
  s_lshr_b32 s93, s91, 3
  s_lshl_b32 s93, s93, 3
  s_add_u32 s93, s93, s90
  s_lshl_b32 s93, s93, 1
  s_lshl_b32 s94, s63, 1
  s_add_u32 s94, s91, s94
  s_and_b32 s94, s94, 7
  s_lshl_b32 s93, s93, 14
  s_lshl_b32 s94, s94, 12
  s_add_u32 s93, s93, s94
  s_add_u32 s92, s93, s74
  s_waitcnt vmcnt(6)
  buffer_load_dwordx4 a[48:51], v2, s[28:31], s92 offen offset:0 nt
  s_waitcnt vmcnt(6)
  buffer_load_dwordx4 a[52:55], v2, s[28:31], s92 offen offset:1024 nt
  s_waitcnt vmcnt(6)
  buffer_load_dwordx4 a[56:59], v2, s[28:31], s92 offen offset:2048 nt
  s_waitcnt vmcnt(6)
  buffer_load_dwordx4 a[60:63], v2, s[28:31], s92 offen offset:3072 nt
  s_add_u32 s91, s3, 44
  s_lshr_b32 s93, s91, 3
  s_lshl_b32 s93, s93, 3
  s_add_u32 s93, s93, s90
  s_lshl_b32 s93, s93, 1
  s_lshl_b32 s94, s63, 1
  s_add_u32 s94, s91, s94
  s_and_b32 s94, s94, 7
  s_lshl_b32 s93, s93, 14
  s_lshl_b32 s94, s94, 12
  s_add_u32 s93, s93, s94
  s_add_u32 s92, s93, s74
  s_waitcnt vmcnt(6)
  buffer_load_dwordx4 a[240:243], v2, s[28:31], s92 offen offset:0 nt
  s_waitcnt vmcnt(6)
  buffer_load_dwordx4 a[244:247], v2, s[28:31], s92 offen offset:1024 nt
  s_waitcnt vmcnt(6)
  buffer_load_dwordx4 a[248:251], v2, s[28:31], s92 offen offset:2048 nt
  s_waitcnt vmcnt(6)
  buffer_load_dwordx4 a[252:255], v2, s[28:31], s92 offen offset:3072 nt
L_waitq:
  ds_read_b64 v[238:239], v1 offset:256
  s_waitcnt lgkmcnt(0)
  v_or_b32 v240, v238, v239
  v_cmp_eq_u32 vcc, 0, v240
  s_cbranch_vccnz L_waitq
  v_readfirstlane_b32 s80, v238
  v_readfirstlane_b32 s81, v239
  s_nop 0
  s_getreg_b32 s82, hwreg(HW_REG_XCC_ID, 0, 4)
  s_add_u32 s82, s82, 1
  s_lshl_b32 s82, s82, 24
  s_xor_b32 s82, s82, s81
  v_and_b32 v236, 3, v0
  v_lshl_add_u32 v236, v14, 2, v236
  v_lshlrev_b32 v236, 4, v236
  ds_read_b128 v[24:27], v236 offset:0
  v_bfe_u32 v237, v0, 2, 2
  s_waitcnt lgkmcnt(0)
  v_cmp_eq_u32 vcc, 0, v237
  s_nop 1
  v_cndmask_b32 v36, 0, v24, vcc
  v_cndmask_b32 v37, 0, v25, vcc
  v_cndmask_b32 v38, 0, v26, vcc
  v_cndmask_b32 v39, 0, v27, vcc
  v_cmp_eq_u32 vcc, 1, v237
  s_nop 1
  v_cndmask_b32 v40, 0, v24, vcc
  v_cndmask_b32 v41, 0, v25, vcc
  v_cndmask_b32 v42, 0, v26, vcc
  v_cndmask_b32 v43, 0, v27, vcc
  v_cmp_eq_u32 vcc, 2, v237
  s_nop 1
  v_cndmask_b32 v44, 0, v24, vcc
  v_cndmask_b32 v45, 0, v25, vcc
  v_cndmask_b32 v46, 0, v26, vcc
  v_cndmask_b32 v47, 0, v27, vcc
  v_cmp_eq_u32 vcc, 3, v237
  s_nop 1
  v_cndmask_b32 v48, 0, v24, vcc
  v_cndmask_b32 v49, 0, v25, vcc
  v_cndmask_b32 v50, 0, v26, vcc
  v_cndmask_b32 v51, 0, v27, vcc
  s_waitcnt vmcnt(59)
  v_mfma_f32_16x16x32_bf16 v[16:19], a[0:3], v[36:39], 0
  v_mfma_f32_16x16x32_bf16 v[16:19], a[4:7], v[40:43], v[16:19]
  v_mfma_f32_16x16x32_bf16 v[16:19], a[8:11], v[44:47], v[16:19]
  v_mfma_f32_16x16x32_bf16 v[16:19], a[12:15], v[48:51], v[16:19]
  s_add_u32 s66, s3, -1
  s_lshl_b32 s66, s66, 8
  v_add_u32 v231, s66, v230
  s_add_u32 s91, s3, 47
  s_lshr_b32 s93, s91, 3
  s_lshl_b32 s93, s93, 3
  s_add_u32 s93, s93, s90
  s_lshl_b32 s93, s93, 1
  s_lshl_b32 s94, s63, 1
  s_add_u32 s94, s91, s94
  s_and_b32 s94, s94, 7
  s_lshl_b32 s93, s93, 14
  s_lshl_b32 s94, s94, 12
  s_add_u32 s93, s93, s94
  s_add_u32 s92, s93, s74
  s_lshl_b32 s36, s91, 8
  v_mul_f32_dpp v24, v16, v6 quad_perm:[0,0,0,0] row_mask:0xf bank_mask:0xf
  v_mul_f32_dpp v25, v17, v6 quad_perm:[1,1,1,1] row_mask:0xf bank_mask:0xf
  v_mul_f32_dpp v26, v18, v6 quad_perm:[2,2,2,2] row_mask:0xf bank_mask:0xf
  v_mul_f32_dpp v27, v19, v6 quad_perm:[3,3,3,3] row_mask:0xf bank_mask:0xf
  v_add_f32 v24, v24, v25
  v_add_f32 v26, v26, v27
  v_add_f32 v7, v24, v26
  v_max_f32 v4, v4, v7
  ds_write_b32 v231, v7 offset:4096
  s_waitcnt vmcnt(5)
  buffer_load_dwordx4 a[0:3], v2, s[28:31], s92 offen offset:0 nt
  s_waitcnt vmcnt(6)
  buffer_load_dwordx4 a[4:7], v2, s[28:31], s92 offen offset:1024 nt
  s_waitcnt vmcnt(6)
  buffer_load_dwordx4 a[8:11], v2, s[28:31], s92 offen offset:2048 nt
  s_waitcnt vmcnt(6)
  buffer_load_dwordx4 a[12:15], v2, s[28:31], s92 offen offset:3072 nt
  s_waitcnt vmcnt(59)
  v_mfma_f32_16x16x32_bf16 v[16:19], a[64:67], v[36:39], 0
  v_mfma_f32_16x16x32_bf16 v[16:19], a[68:71], v[40:43], v[16:19]
  v_mfma_f32_16x16x32_bf16 v[16:19], a[72:75], v[44:47], v[16:19]
  v_mfma_f32_16x16x32_bf16 v[16:19], a[76:79], v[48:51], v[16:19]
  s_add_u32 s66, s3, 2
  s_lshl_b32 s66, s66, 8
  v_add_u32 v231, s66, v230
  s_nop 4
  v_mul_f32_dpp v24, v16, v6 quad_perm:[0,0,0,0] row_mask:0xf bank_mask:0xf
  v_mul_f32_dpp v25, v17, v6 quad_perm:[1,1,1,1] row_mask:0xf bank_mask:0xf
  v_mul_f32_dpp v26, v18, v6 quad_perm:[2,2,2,2] row_mask:0xf bank_mask:0xf
  v_mul_f32_dpp v27, v19, v6 quad_perm:[3,3,3,3] row_mask:0xf bank_mask:0xf
  v_add_f32 v24, v24, v25
  v_add_f32 v26, v26, v27
  v_add_f32 v7, v24, v26
  v_max_f32 v4, v4, v7
  ds_write_b32 v231, v7 offset:4096
  s_waitcnt vmcnt(56)
  v_mfma_f32_16x16x32_bf16 v[16:19], a[80:83], v[36:39], 0
  v_mfma_f32_16x16x32_bf16 v[16:19], a[84:87], v[40:43], v[16:19]
  v_mfma_f32_16x16x32_bf16 v[16:19], a[88:91], v[44:47], v[16:19]
  v_mfma_f32_16x16x32_bf16 v[16:19], a[92:95], v[48:51], v[16:19]
  s_add_u32 s66, s3, 5
  s_lshl_b32 s66, s66, 8
  v_add_u32 v231, s66, v230
  s_add_u32 s91, s3, 50
  s_lshr_b32 s93, s91, 3
  s_lshl_b32 s93, s93, 3
  s_add_u32 s93, s93, s90
  s_lshl_b32 s93, s93, 1
  s_lshl_b32 s94, s63, 1
  s_add_u32 s94, s91, s94
  s_and_b32 s94, s94, 7
  s_lshl_b32 s93, s93, 14
  s_lshl_b32 s94, s94, 12
  s_add_u32 s93, s93, s94
  s_add_u32 s92, s93, s74
  v_mul_f32_dpp v24, v16, v6 quad_perm:[0,0,0,0] row_mask:0xf bank_mask:0xf
  v_mul_f32_dpp v25, v17, v6 quad_perm:[1,1,1,1] row_mask:0xf bank_mask:0xf
  v_mul_f32_dpp v26, v18, v6 quad_perm:[2,2,2,2] row_mask:0xf bank_mask:0xf
  v_mul_f32_dpp v27, v19, v6 quad_perm:[3,3,3,3] row_mask:0xf bank_mask:0xf
  v_add_f32 v24, v24, v25
  v_add_f32 v26, v26, v27
  v_add_f32 v7, v24, v26
  v_max_f32 v4, v4, v7
  ds_write_b32 v231, v7 offset:4096
  s_waitcnt vmcnt(5)
  buffer_load_dwordx4 a[80:83], v2, s[28:31], s92 offen offset:0 nt
  s_waitcnt vmcnt(6)
  buffer_load_dwordx4 a[84:87], v2, s[28:31], s92 offen offset:1024 nt
  s_waitcnt vmcnt(6)
  buffer_load_dwordx4 a[88:91], v2, s[28:31], s92 offen offset:2048 nt
  s_waitcnt vmcnt(6)
  buffer_load_dwordx4 a[92:95], v2, s[28:31], s92 offen offset:3072 nt
  s_waitcnt vmcnt(56)
  v_mfma_f32_16x16x32_bf16 v[16:19], a[96:99], v[36:39], 0
  v_mfma_f32_16x16x32_bf16 v[16:19], a[100:103], v[40:43], v[16:19]
  v_mfma_f32_16x16x32_bf16 v[16:19], a[104:107], v[44:47], v[16:19]
  v_mfma_f32_16x16x32_bf16 v[16:19], a[108:111], v[48:51], v[16:19]
  s_add_u32 s66, s3, 8
  s_lshl_b32 s66, s66, 8
  v_add_u32 v231, s66, v230
  s_nop 4
  v_mul_f32_dpp v24, v16, v6 quad_perm:[0,0,0,0] row_mask:0xf bank_mask:0xf
  v_mul_f32_dpp v25, v17, v6 quad_perm:[1,1,1,1] row_mask:0xf bank_mask:0xf
  v_mul_f32_dpp v26, v18, v6 quad_perm:[2,2,2,2] row_mask:0xf bank_mask:0xf
  v_mul_f32_dpp v27, v19, v6 quad_perm:[3,3,3,3] row_mask:0xf bank_mask:0xf
  v_add_f32 v24, v24, v25
  v_add_f32 v26, v26, v27
  v_add_f32 v7, v24, v26
  v_max_f32 v4, v4, v7
  ds_write_b32 v231, v7 offset:4096
  s_waitcnt vmcnt(52)
  v_mfma_f32_16x16x32_bf16 v[16:19], a[16:19], v[36:39], 0
  v_mfma_f32_16x16x32_bf16 v[16:19], a[20:23], v[40:43], v[16:19]
  v_mfma_f32_16x16x32_bf16 v[16:19], a[24:27], v[44:47], v[16:19]
  v_mfma_f32_16x16x32_bf16 v[16:19], a[28:31], v[48:51], v[16:19]
  s_add_u32 s66, s3, 11
  s_lshl_b32 s66, s66, 8
  v_add_u32 v231, s66, v230
  s_add_u32 s91, s3, 53
  s_lshr_b32 s93, s91, 3
  s_lshl_b32 s93, s93, 3
  s_add_u32 s93, s93, s90
  s_lshl_b32 s93, s93, 1
  s_lshl_b32 s94, s63, 1
  s_add_u32 s94, s91, s94
  s_and_b32 s94, s94, 7
  s_lshl_b32 s93, s93, 14
  s_lshl_b32 s94, s94, 12
  s_add_u32 s93, s93, s94
  s_add_u32 s92, s93, s74
  s_lshl_b32 s37, s91, 8
  v_mul_f32_dpp v24, v16, v6 quad_perm:[0,0,0,0] row_mask:0xf bank_mask:0xf
  v_mul_f32_dpp v25, v17, v6 quad_perm:[1,1,1,1] row_mask:0xf bank_mask:0xf
  v_mul_f32_dpp v26, v18, v6 quad_perm:[2,2,2,2] row_mask:0xf bank_mask:0xf
  v_mul_f32_dpp v27, v19, v6 quad_perm:[3,3,3,3] row_mask:0xf bank_mask:0xf
  v_add_f32 v24, v24, v25
  v_add_f32 v26, v26, v27
  v_add_f32 v7, v24, v26
  v_max_f32 v4, v4, v7
  ds_write_b32 v231, v7 offset:4096
  s_waitcnt vmcnt(5)
  buffer_load_dwordx4 a[16:19], v2, s[28:31], s92 offen offset:0 nt
  s_waitcnt vmcnt(6)
  buffer_load_dwordx4 a[20:23], v2, s[28:31], s92 offen offset:1024 nt
  s_waitcnt vmcnt(6)
  buffer_load_dwordx4 a[24:27], v2, s[28:31], s92 offen offset:2048 nt
  s_waitcnt vmcnt(6)
  buffer_load_dwordx4 a[28:31], v2, s[28:31], s92 offen offset:3072 nt
  s_waitcnt vmcnt(52)
  v_mfma_f32_16x16x32_bf16 v[16:19], a[112:115], v[36:39], 0
  v_mfma_f32_16x16x32_bf16 v[16:19], a[116:119], v[40:43], v[16:19]
  v_mfma_f32_16x16x32_bf16 v[16:19], a[120:123], v[44:47], v[16:19]
  v_mfma_f32_16x16x32_bf16 v[16:19], a[124:127], v[48:51], v[16:19]
  s_add_u32 s66, s3, 14
  s_lshl_b32 s66, s66, 8
  v_add_u32 v231, s66, v230
  s_nop 4
  v_mul_f32_dpp v24, v16, v6 quad_perm:[0,0,0,0] row_mask:0xf bank_mask:0xf
  v_mul_f32_dpp v25, v17, v6 quad_perm:[1,1,1,1] row_mask:0xf bank_mask:0xf
  v_mul_f32_dpp v26, v18, v6 quad_perm:[2,2,2,2] row_mask:0xf bank_mask:0xf
  v_mul_f32_dpp v27, v19, v6 quad_perm:[3,3,3,3] row_mask:0xf bank_mask:0xf
  v_add_f32 v24, v24, v25
  v_add_f32 v26, v26, v27
  v_add_f32 v7, v24, v26
  v_max_f32 v4, v4, v7
  ds_write_b32 v231, v7 offset:4096
  s_waitcnt vmcnt(48)
  v_mfma_f32_16x16x32_bf16 v[16:19], a[128:131], v[36:39], 0
  v_mfma_f32_16x16x32_bf16 v[16:19], a[132:135], v[40:43], v[16:19]
  v_mfma_f32_16x16x32_bf16 v[16:19], a[136:139], v[44:47], v[16:19]
  v_mfma_f32_16x16x32_bf16 v[16:19], a[140:143], v[48:51], v[16:19]
  s_add_u32 s66, s3, 17
  s_lshl_b32 s66, s66, 8
  v_add_u32 v231, s66, v230
  s_add_u32 s91, s3, 56
  s_lshr_b32 s93, s91, 3
  s_lshl_b32 s93, s93, 3
  s_add_u32 s93, s93, s90
  s_lshl_b32 s93, s93, 1
  s_lshl_b32 s94, s63, 1
  s_add_u32 s94, s91, s94
  s_and_b32 s94, s94, 7
  s_lshl_b32 s93, s93, 14
  s_lshl_b32 s94, s94, 12
  s_add_u32 s93, s93, s94
  s_add_u32 s92, s93, s74
  v_mul_f32_dpp v24, v16, v6 quad_perm:[0,0,0,0] row_mask:0xf bank_mask:0xf
  v_mul_f32_dpp v25, v17, v6 quad_perm:[1,1,1,1] row_mask:0xf bank_mask:0xf
  v_mul_f32_dpp v26, v18, v6 quad_perm:[2,2,2,2] row_mask:0xf bank_mask:0xf
  v_mul_f32_dpp v27, v19, v6 quad_perm:[3,3,3,3] row_mask:0xf bank_mask:0xf
  v_add_f32 v24, v24, v25
  v_add_f32 v26, v26, v27
  v_add_f32 v7, v24, v26
  v_max_f32 v4, v4, v7
  ds_write_b32 v231, v7 offset:4096
  s_waitcnt vmcnt(5)
  buffer_load_dwordx4 a[128:131], v2, s[28:31], s92 offen offset:0 nt
  s_waitcnt vmcnt(6)
  buffer_load_dwordx4 a[132:135], v2, s[28:31], s92 offen offset:1024 nt
  s_waitcnt vmcnt(6)
  buffer_load_dwordx4 a[136:139], v2, s[28:31], s92 offen offset:2048 nt
  s_waitcnt vmcnt(6)
  buffer_load_dwordx4 a[140:143], v2, s[28:31], s92 offen offset:3072 nt
  s_waitcnt vmcnt(48)
  v_mfma_f32_16x16x32_bf16 v[16:19], a[144:147], v[36:39], 0
  v_mfma_f32_16x16x32_bf16 v[16:19], a[148:151], v[40:43], v[16:19]
  v_mfma_f32_16x16x32_bf16 v[16:19], a[152:155], v[44:47], v[16:19]
  v_mfma_f32_16x16x32_bf16 v[16:19], a[156:159], v[48:51], v[16:19]
  s_add_u32 s66, s3, 20
  s_lshl_b32 s66, s66, 8
  v_add_u32 v231, s66, v230
  s_nop 4
  v_mul_f32_dpp v24, v16, v6 quad_perm:[0,0,0,0] row_mask:0xf bank_mask:0xf
  v_mul_f32_dpp v25, v17, v6 quad_perm:[1,1,1,1] row_mask:0xf bank_mask:0xf
  v_mul_f32_dpp v26, v18, v6 quad_perm:[2,2,2,2] row_mask:0xf bank_mask:0xf
  v_mul_f32_dpp v27, v19, v6 quad_perm:[3,3,3,3] row_mask:0xf bank_mask:0xf
  v_add_f32 v24, v24, v25
  v_add_f32 v26, v26, v27
  v_add_f32 v7, v24, v26
  v_max_f32 v4, v4, v7
  ds_write_b32 v231, v7 offset:4096
  s_waitcnt vmcnt(44)
  v_mfma_f32_16x16x32_bf16 v[16:19], a[160:163], v[36:39], 0
  v_mfma_f32_16x16x32_bf16 v[16:19], a[164:167], v[40:43], v[16:19]
  v_mfma_f32_16x16x32_bf16 v[16:19], a[168:171], v[44:47], v[16:19]
  v_mfma_f32_16x16x32_bf16 v[16:19], a[172:175], v[48:51], v[16:19]
  s_add_u32 s66, s3, 23
  s_lshl_b32 s66, s66, 8
  v_add_u32 v231, s66, v230
  s_add_u32 s91, s3, 59
  s_lshr_b32 s93, s91, 3
  s_lshl_b32 s93, s93, 3
  s_add_u32 s93, s93, s90
  s_lshl_b32 s93, s93, 1
  s_lshl_b32 s94, s63, 1
  s_add_u32 s94, s91, s94
  s_and_b32 s94, s94, 7
  s_lshl_b32 s93, s93, 14
  s_lshl_b32 s94, s94, 12
  s_add_u32 s93, s93, s94
  s_add_u32 s92, s93, s74
  v_mul_f32_dpp v24, v16, v6 quad_perm:[0,0,0,0] row_mask:0xf bank_mask:0xf
  v_mul_f32_dpp v25, v17, v6 quad_perm:[1,1,1,1] row_mask:0xf bank_mask:0xf
  v_mul_f32_dpp v26, v18, v6 quad_perm:[2,2,2,2] row_mask:0xf bank_mask:0xf
  v_mul_f32_dpp v27, v19, v6 quad_perm:[3,3,3,3] row_mask:0xf bank_mask:0xf
  v_add_f32 v24, v24, v25
  v_add_f32 v26, v26, v27
  v_add_f32 v7, v24, v26
  v_max_f32 v4, v4, v7
  ds_write_b32 v231, v7 offset:4096
  s_waitcnt vmcnt(5)
  buffer_load_dwordx4 a[160:163], v2, s[28:31], s92 offen offset:0 nt
  s_waitcnt vmcnt(6)
  buffer_load_dwordx4 a[164:167], v2, s[28:31], s92 offen offset:1024 nt
  s_waitcnt vmcnt(6)
  buffer_load_dwordx4 a[168:171], v2, s[28:31], s92 offen offset:2048 nt
  s_waitcnt vmcnt(6)
  buffer_load_dwordx4 a[172:175], v2, s[28:31], s92 offen offset:3072 nt
  s_waitcnt vmcnt(44)
  v_mfma_f32_16x16x32_bf16 v[16:19], a[176:179], v[36:39], 0
  v_mfma_f32_16x16x32_bf16 v[16:19], a[180:183], v[40:43], v[16:19]
  v_mfma_f32_16x16x32_bf16 v[16:19], a[184:187], v[44:47], v[16:19]
  v_mfma_f32_16x16x32_bf16 v[16:19], a[188:191], v[48:51], v[16:19]
  s_add_u32 s66, s3, 26
  s_lshl_b32 s66, s66, 8
  v_add_u32 v231, s66, v230
  s_nop 4
  v_mul_f32_dpp v24, v16, v6 quad_perm:[0,0,0,0] row_mask:0xf bank_mask:0xf
  v_mul_f32_dpp v25, v17, v6 quad_perm:[1,1,1,1] row_mask:0xf bank_mask:0xf
  v_mul_f32_dpp v26, v18, v6 quad_perm:[2,2,2,2] row_mask:0xf bank_mask:0xf
  v_mul_f32_dpp v27, v19, v6 quad_perm:[3,3,3,3] row_mask:0xf bank_mask:0xf
  v_add_f32 v24, v24, v25
  v_add_f32 v26, v26, v27
  v_add_f32 v7, v24, v26
  v_max_f32 v4, v4, v7
  ds_write_b32 v231, v7 offset:4096
  s_waitcnt vmcnt(40)
  v_mfma_f32_16x16x32_bf16 v[16:19], a[32:35], v[36:39], 0
  v_mfma_f32_16x16x32_bf16 v[16:19], a[36:39], v[40:43], v[16:19]
  v_mfma_f32_16x16x32_bf16 v[16:19], a[40:43], v[44:47], v[16:19]
  v_mfma_f32_16x16x32_bf16 v[16:19], a[44:47], v[48:51], v[16:19]
  s_add_u32 s66, s3, 29
  s_lshl_b32 s66, s66, 8
  v_add_u32 v231, s66, v230
  s_add_u32 s91, s3, 62
  s_lshr_b32 s93, s91, 3
  s_lshl_b32 s93, s93, 3
  s_add_u32 s93, s93, s90
  s_lshl_b32 s93, s93, 1
  s_lshl_b32 s94, s63, 1
  s_add_u32 s94, s91, s94
  s_and_b32 s94, s94, 7
  s_lshl_b32 s93, s93, 14
  s_lshl_b32 s94, s94, 12
  s_add_u32 s93, s93, s94
  s_add_u32 s92, s93, s74
  s_lshl_b32 s38, s91, 8
  v_mul_f32_dpp v24, v16, v6 quad_perm:[0,0,0,0] row_mask:0xf bank_mask:0xf
  v_mul_f32_dpp v25, v17, v6 quad_perm:[1,1,1,1] row_mask:0xf bank_mask:0xf
  v_mul_f32_dpp v26, v18, v6 quad_perm:[2,2,2,2] row_mask:0xf bank_mask:0xf
  v_mul_f32_dpp v27, v19, v6 quad_perm:[3,3,3,3] row_mask:0xf bank_mask:0xf
  v_add_f32 v24, v24, v25
  v_add_f32 v26, v26, v27
  v_add_f32 v7, v24, v26
  v_max_f32 v4, v4, v7
  ds_write_b32 v231, v7 offset:4096
  s_waitcnt vmcnt(5)
  buffer_load_dwordx4 a[32:35], v2, s[28:31], s92 offen offset:0 nt
  s_waitcnt vmcnt(6)
  buffer_load_dwordx4 a[36:39], v2, s[28:31], s92 offen offset:1024 nt
  s_waitcnt vmcnt(6)
  buffer_load_dwordx4 a[40:43], v2, s[28:31], s92 offen offset:2048 nt
  s_waitcnt vmcnt(6)
  buffer_load_dwordx4 a[44:47], v2, s[28:31], s92 offen offset:3072 nt
  s_waitcnt vmcnt(40)
  v_mfma_f32_16x16x32_bf16 v[16:19], a[192:195], v[36:39], 0
  v_mfma_f32_16x16x32_bf16 v[16:19], a[196:199], v[40:43], v[16:19]
  v_mfma_f32_16x16x32_bf16 v[16:19], a[200:203], v[44:47], v[16:19]
  v_mfma_f32_16x16x32_bf16 v[16:19], a[204:207], v[48:51], v[16:19]
  s_add_u32 s66, s3, 32
  s_lshl_b32 s66, s66, 8
  v_add_u32 v231, s66, v230
  s_nop 4
  v_mul_f32_dpp v24, v16, v6 quad_perm:[0,0,0,0] row_mask:0xf bank_mask:0xf
  v_mul_f32_dpp v25, v17, v6 quad_perm:[1,1,1,1] row_mask:0xf bank_mask:0xf
  v_mul_f32_dpp v26, v18, v6 quad_perm:[2,2,2,2] row_mask:0xf bank_mask:0xf
  v_mul_f32_dpp v27, v19, v6 quad_perm:[3,3,3,3] row_mask:0xf bank_mask:0xf
  v_add_f32 v24, v24, v25
  v_add_f32 v26, v26, v27
  v_add_f32 v7, v24, v26
  v_max_f32 v4, v4, v7
  ds_write_b32 v231, v7 offset:4096
  s_waitcnt vmcnt(36)
  v_mfma_f32_16x16x32_bf16 v[16:19], a[208:211], v[36:39], 0
  v_mfma_f32_16x16x32_bf16 v[16:19], a[212:215], v[40:43], v[16:19]
  v_mfma_f32_16x16x32_bf16 v[16:19], a[216:219], v[44:47], v[16:19]
  v_mfma_f32_16x16x32_bf16 v[16:19], a[220:223], v[48:51], v[16:19]
  s_add_u32 s66, s3, 35
  s_lshl_b32 s66, s66, 8
  v_add_u32 v231, s66, v230
  s_add_u32 s91, s3, 65
  s_lshr_b32 s93, s91, 3
  s_lshl_b32 s93, s93, 3
  s_add_u32 s93, s93, s90
  s_lshl_b32 s93, s93, 1
  s_lshl_b32 s94, s63, 1
  s_add_u32 s94, s91, s94
  s_and_b32 s94, s94, 7
  s_lshl_b32 s93, s93, 14
  s_lshl_b32 s94, s94, 12
  s_add_u32 s93, s93, s94
  s_add_u32 s92, s93, s74
  v_mul_f32_dpp v24, v16, v6 quad_perm:[0,0,0,0] row_mask:0xf bank_mask:0xf
  v_mul_f32_dpp v25, v17, v6 quad_perm:[1,1,1,1] row_mask:0xf bank_mask:0xf
  v_mul_f32_dpp v26, v18, v6 quad_perm:[2,2,2,2] row_mask:0xf bank_mask:0xf
  v_mul_f32_dpp v27, v19, v6 quad_perm:[3,3,3,3] row_mask:0xf bank_mask:0xf
  v_add_f32 v24, v24, v25
  v_add_f32 v26, v26, v27
  v_add_f32 v7, v24, v26
  v_max_f32 v4, v4, v7
  ds_write_b32 v231, v7 offset:4096
  s_waitcnt vmcnt(5)
  buffer_load_dwordx4 a[208:211], v2, s[28:31], s92 offen offset:0 nt
  s_waitcnt vmcnt(6)
  buffer_load_dwordx4 a[212:215], v2, s[28:31], s92 offen offset:1024 nt
  s_waitcnt vmcnt(6)
  buffer_load_dwordx4 a[216:219], v2, s[28:31], s92 offen offset:2048 nt
  s_waitcnt vmcnt(6)
  buffer_load_dwordx4 a[220:223], v2, s[28:31], s92 offen offset:3072 nt
  s_waitcnt vmcnt(36)
  v_mfma_f32_16x16x32_bf16 v[16:19], a[224:227], v[36:39], 0
  v_mfma_f32_16x16x32_bf16 v[16:19], a[228:231], v[40:43], v[16:19]
  v_mfma_f32_16x16x32_bf16 v[16:19], a[232:235], v[44:47], v[16:19]
  v_mfma_f32_16x16x32_bf16 v[16:19], a[236:239], v[48:51], v[16:19]
  s_add_u32 s66, s3, 38
  s_lshl_b32 s66, s66, 8
  v_add_u32 v231, s66, v230
  s_nop 4
  v_mul_f32_dpp v24, v16, v6 quad_perm:[0,0,0,0] row_mask:0xf bank_mask:0xf
  v_mul_f32_dpp v25, v17, v6 quad_perm:[1,1,1,1] row_mask:0xf bank_mask:0xf
  v_mul_f32_dpp v26, v18, v6 quad_perm:[2,2,2,2] row_mask:0xf bank_mask:0xf
  v_mul_f32_dpp v27, v19, v6 quad_perm:[3,3,3,3] row_mask:0xf bank_mask:0xf
  v_add_f32 v24, v24, v25
  v_add_f32 v26, v26, v27
  v_add_f32 v7, v24, v26
  v_max_f32 v4, v4, v7
  ds_write_b32 v231, v7 offset:4096
  s_waitcnt vmcnt(32)
  v_mfma_f32_16x16x32_bf16 v[16:19], a[48:51], v[36:39], 0
  v_mfma_f32_16x16x32_bf16 v[16:19], a[52:55], v[40:43], v[16:19]
  v_mfma_f32_16x16x32_bf16 v[16:19], a[56:59], v[44:47], v[16:19]
  v_mfma_f32_16x16x32_bf16 v[16:19], a[60:63], v[48:51], v[16:19]
  s_add_u32 s66, s3, 41
  s_lshl_b32 s66, s66, 8
  v_add_u32 v231, s66, v230
  s_add_u32 s91, s3, 68
  s_lshr_b32 s93, s91, 3
  s_lshl_b32 s93, s93, 3
  s_add_u32 s93, s93, s90
  s_lshl_b32 s93, s93, 1
  s_lshl_b32 s94, s63, 1
  s_add_u32 s94, s91, s94
  s_and_b32 s94, s94, 7
  s_lshl_b32 s93, s93, 14
  s_lshl_b32 s94, s94, 12
  s_add_u32 s93, s93, s94
  s_add_u32 s92, s93, s74
  s_lshl_b32 s39, s91, 8
  v_mul_f32_dpp v24, v16, v6 quad_perm:[0,0,0,0] row_mask:0xf bank_mask:0xf
  v_mul_f32_dpp v25, v17, v6 quad_perm:[1,1,1,1] row_mask:0xf bank_mask:0xf
  v_mul_f32_dpp v26, v18, v6 quad_perm:[2,2,2,2] row_mask:0xf bank_mask:0xf
  v_mul_f32_dpp v27, v19, v6 quad_perm:[3,3,3,3] row_mask:0xf bank_mask:0xf
  v_add_f32 v24, v24, v25
  v_add_f32 v26, v26, v27
  v_add_f32 v7, v24, v26
  v_max_f32 v4, v4, v7
  ds_write_b32 v231, v7 offset:4096
  s_waitcnt vmcnt(5)
  buffer_load_dwordx4 a[48:51], v2, s[28:31], s92 offen offset:0 nt
  s_waitcnt vmcnt(6)
  buffer_load_dwordx4 a[52:55], v2, s[28:31], s92 offen offset:1024 nt
  s_waitcnt vmcnt(6)
  buffer_load_dwordx4 a[56:59], v2, s[28:31], s92 offen offset:2048 nt
  s_waitcnt vmcnt(6)
  buffer_load_dwordx4 a[60:63], v2, s[28:31], s92 offen offset:3072 nt
  s_waitcnt vmcnt(32)
  v_mfma_f32_16x16x32_bf16 v[16:19], a[240:243], v[36:39], 0
  v_mfma_f32_16x16x32_bf16 v[16:19], a[244:247], v[40:43], v[16:19]
  v_mfma_f32_16x16x32_bf16 v[16:19], a[248:251], v[44:47], v[16:19]
  v_mfma_f32_16x16x32_bf16 v[16:19], a[252:255], v[48:51], v[16:19]
  s_add_u32 s66, s3, 44
  s_lshl_b32 s66, s66, 8
  v_add_u32 v231, s66, v230
  s_nop 4
  v_mul_f32_dpp v24, v16, v6 quad_perm:[0,0,0,0] row_mask:0xf bank_mask:0xf
  v_mul_f32_dpp v25, v17, v6 quad_perm:[1,1,1,1] row_mask:0xf bank_mask:0xf
  v_mul_f32_dpp v26, v18, v6 quad_perm:[2,2,2,2] row_mask:0xf bank_mask:0xf
  v_mul_f32_dpp v27, v19, v6 quad_perm:[3,3,3,3] row_mask:0xf bank_mask:0xf
  v_add_f32 v24, v24, v25
  v_add_f32 v26, v26, v27
  v_add_f32 v7, v24, v26
  v_max_f32 v4, v4, v7
  ds_write_b32 v231, v7 offset:4096
  s_waitcnt vmcnt(28)
  v_mfma_f32_16x16x32_bf16 v[16:19], a[0:3], v[36:39], 0
  v_mfma_f32_16x16x32_bf16 v[16:19], a[4:7], v[40:43], v[16:19]
  v_mfma_f32_16x16x32_bf16 v[16:19], a[8:11], v[44:47], v[16:19]
  v_mfma_f32_16x16x32_bf16 v[16:19], a[12:15], v[48:51], v[16:19]
  s_add_u32 s66, s3, 47
  s_lshl_b32 s66, s66, 8
  v_add_u32 v231, s66, v230
  s_add_u32 s91, s3, 71
  s_lshr_b32 s93, s91, 3
  s_lshl_b32 s93, s93, 3
  s_add_u32 s93, s93, s90
  s_lshl_b32 s93, s93, 1
  s_lshl_b32 s94, s63, 1
  s_add_u32 s94, s91, s94
  s_and_b32 s94, s94, 7
  s_lshl_b32 s93, s93, 14
  s_lshl_b32 s94, s94, 12
  s_add_u32 s93, s93, s94
  s_add_u32 s92, s93, s74
  s_lshl_b32 s36, s91, 8
  v_mul_f32_dpp v24, v16, v6 quad_perm:[0,0,0,0] row_mask:0xf bank_mask:0xf
  v_mul_f32_dpp v25, v17, v6 quad_perm:[1,1,1,1] row_mask:0xf bank_mask:0xf
  v_mul_f32_dpp v26, v18, v6 quad_perm:[2,2,2,2] row_mask:0xf bank_mask:0xf
  v_mul_f32_dpp v27, v19, v6 quad_perm:[3,3,3,3] row_mask:0xf bank_mask:0xf
  v_add_f32 v24, v24, v25
  v_add_f32 v26, v26, v27
  v_add_f32 v7, v24, v26
  v_max_f32 v4, v4, v7
  ds_write_b32 v231, v7 offset:4096
  s_waitcnt vmcnt(5)
  buffer_load_dwordx4 a[0:3], v2, s[28:31], s92 offen offset:0 nt
  s_waitcnt vmcnt(6)
  buffer_load_dwordx4 a[4:7], v2, s[28:31], s92 offen offset:1024 nt
  s_waitcnt vmcnt(6)
  buffer_load_dwordx4 a[8:11], v2, s[28:31], s92 offen offset:2048 nt
  s_waitcnt vmcnt(6)
  buffer_load_dwordx4 a[12:15], v2, s[28:31], s92 offen offset:3072 nt
  s_waitcnt vmcnt(28)
  v_mfma_f32_16x16x32_bf16 v[16:19], a[80:83], v[36:39], 0
  v_mfma_f32_16x16x32_bf16 v[16:19], a[84:87], v[40:43], v[16:19]
  v_mfma_f32_16x16x32_bf16 v[16:19], a[88:91], v[44:47], v[16:19]
  v_mfma_f32_16x16x32_bf16 v[16:19], a[92:95], v[48:51], v[16:19]
  s_add_u32 s66, s3, 50
  s_lshl_b32 s66, s66, 8
  v_add_u32 v231, s66, v230
  s_nop 4
  v_mul_f32_dpp v24, v16, v6 quad_perm:[0,0,0,0] row_mask:0xf bank_mask:0xf
  v_mul_f32_dpp v25, v17, v6 quad_perm:[1,1,1,1] row_mask:0xf bank_mask:0xf
  v_mul_f32_dpp v26, v18, v6 quad_perm:[2,2,2,2] row_mask:0xf bank_mask:0xf
  v_mul_f32_dpp v27, v19, v6 quad_perm:[3,3,3,3] row_mask:0xf bank_mask:0xf
  v_add_f32 v24, v24, v25
  v_add_f32 v26, v26, v27
  v_add_f32 v7, v24, v26
  v_max_f32 v4, v4, v7
  ds_write_b32 v231, v7 offset:4096
  s_waitcnt vmcnt(24)
  v_mfma_f32_16x16x32_bf16 v[16:19], a[16:19], v[36:39], 0
  v_mfma_f32_16x16x32_bf16 v[16:19], a[20:23], v[40:43], v[16:19]
  v_mfma_f32_16x16x32_bf16 v[16:19], a[24:27], v[44:47], v[16:19]
  v_mfma_f32_16x16x32_bf16 v[16:19], a[28:31], v[48:51], v[16:19]
  s_add_u32 s66, s3, 53
  s_lshl_b32 s66, s66, 8
  v_add_u32 v231, s66, v230
  s_add_u32 s91, s3, 74
  s_lshr_b32 s93, s91, 3
  s_lshl_b32 s93, s93, 3
  s_add_u32 s93, s93, s90
  s_lshl_b32 s93, s93, 1
  s_lshl_b32 s94, s63, 1
  s_add_u32 s94, s91, s94
  s_and_b32 s94, s94, 7
  s_lshl_b32 s93, s93, 14
  s_lshl_b32 s94, s94, 12
  s_add_u32 s93, s93, s94
  s_add_u32 s92, s93, s74
  s_lshl_b32 s37, s91, 8
  v_mul_f32_dpp v24, v16, v6 quad_perm:[0,0,0,0] row_mask:0xf bank_mask:0xf
  v_mul_f32_dpp v25, v17, v6 quad_perm:[1,1,1,1] row_mask:0xf bank_mask:0xf
  v_mul_f32_dpp v26, v18, v6 quad_perm:[2,2,2,2] row_mask:0xf bank_mask:0xf
  v_mul_f32_dpp v27, v19, v6 quad_perm:[3,3,3,3] row_mask:0xf bank_mask:0xf
  v_add_f32 v24, v24, v25
  v_add_f32 v26, v26, v27
  v_add_f32 v7, v24, v26
  v_max_f32 v4, v4, v7
  ds_write_b32 v231, v7 offset:4096
  s_waitcnt vmcnt(5)
  buffer_load_dwordx4 a[16:19], v2, s[28:31], s92 offen offset:0 nt
  s_waitcnt vmcnt(6)
  buffer_load_dwordx4 a[20:23], v2, s[28:31], s92 offen offset:1024 nt
  s_waitcnt vmcnt(6)
  buffer_load_dwordx4 a[24:27], v2, s[28:31], s92 offen offset:2048 nt
  s_waitcnt vmcnt(6)
  buffer_load_dwordx4 a[28:31], v2, s[28:31], s92 offen offset:3072 nt
  s_waitcnt vmcnt(24)
  v_mfma_f32_16x16x32_bf16 v[16:19], a[128:131], v[36:39], 0
  v_mfma_f32_16x16x32_bf16 v[16:19], a[132:135], v[40:43], v[16:19]
  v_mfma_f32_16x16x32_bf16 v[16:19], a[136:139], v[44:47], v[16:19]
  v_mfma_f32_16x16x32_bf16 v[16:19], a[140:143], v[48:51], v[16:19]
  s_add_u32 s66, s3, 56
  s_lshl_b32 s66, s66, 8
  v_add_u32 v231, s66, v230
  s_nop 4
  v_mul_f32_dpp v24, v16, v6 quad_perm:[0,0,0,0] row_mask:0xf bank_mask:0xf
  v_mul_f32_dpp v25, v17, v6 quad_perm:[1,1,1,1] row_mask:0xf bank_mask:0xf
  v_mul_f32_dpp v26, v18, v6 quad_perm:[2,2,2,2] row_mask:0xf bank_mask:0xf
  v_mul_f32_dpp v27, v19, v6 quad_perm:[3,3,3,3] row_mask:0xf bank_mask:0xf
  v_add_f32 v24, v24, v25
  v_add_f32 v26, v26, v27
  v_add_f32 v7, v24, v26
  v_max_f32 v4, v4, v7
  ds_write_b32 v231, v7 offset:4096
  s_waitcnt vmcnt(20)
  v_mfma_f32_16x16x32_bf16 v[16:19], a[160:163], v[36:39], 0
  v_mfma_f32_16x16x32_bf16 v[16:19], a[164:167], v[40:43], v[16:19]
  v_mfma_f32_16x16x32_bf16 v[16:19], a[168:171], v[44:47], v[16:19]
  v_mfma_f32_16x16x32_bf16 v[16:19], a[172:175], v[48:51], v[16:19]
  s_add_u32 s66, s3, 59
  s_lshl_b32 s66, s66, 8
  v_add_u32 v231, s66, v230
  s_nop 4
  v_mul_f32_dpp v24, v16, v6 quad_perm:[0,0,0,0] row_mask:0xf bank_mask:0xf
  v_mul_f32_dpp v25, v17, v6 quad_perm:[1,1,1,1] row_mask:0xf bank_mask:0xf
  v_mul_f32_dpp v26, v18, v6 quad_perm:[2,2,2,2] row_mask:0xf bank_mask:0xf
  v_mul_f32_dpp v27, v19, v6 quad_perm:[3,3,3,3] row_mask:0xf bank_mask:0xf
  v_add_f32 v24, v24, v25
  v_add_f32 v26, v26, v27
  v_add_f32 v7, v24, v26
  v_max_f32 v4, v4, v7
  ds_write_b32 v231, v7 offset:4096
  s_waitcnt vmcnt(16)
  v_mfma_f32_16x16x32_bf16 v[16:19], a[32:35], v[36:39], 0
  v_mfma_f32_16x16x32_bf16 v[16:19], a[36:39], v[40:43], v[16:19]
  v_mfma_f32_16x16x32_bf16 v[16:19], a[40:43], v[44:47], v[16:19]
  v_mfma_f32_16x16x32_bf16 v[16:19], a[44:47], v[48:51], v[16:19]
  s_add_u32 s66, s3, 62
  s_lshl_b32 s66, s66, 8
  v_add_u32 v231, s66, v230
  s_add_u32 s91, s3, 77
  s_lshr_b32 s93, s91, 3
  s_lshl_b32 s93, s93, 3
  s_add_u32 s93, s93, s90
  s_lshl_b32 s93, s93, 1
  s_lshl_b32 s94, s63, 1
  s_add_u32 s94, s91, s94
  s_and_b32 s94, s94, 7
  s_lshl_b32 s93, s93, 14
  s_lshl_b32 s94, s94, 12
  s_add_u32 s93, s93, s94
  s_add_u32 s92, s93, s74
  s_lshl_b32 s38, s91, 8
  v_mul_f32_dpp v24, v16, v6 quad_perm:[0,0,0,0] row_mask:0xf bank_mask:0xf
  v_mul_f32_dpp v25, v17, v6 quad_perm:[1,1,1,1] row_mask:0xf bank_mask:0xf
  v_mul_f32_dpp v26, v18, v6 quad_perm:[2,2,2,2] row_mask:0xf bank_mask:0xf
  v_mul_f32_dpp v27, v19, v6 quad_perm:[3,3,3,3] row_mask:0xf bank_mask:0xf
  v_add_f32 v24, v24, v25
  v_add_f32 v26, v26, v27
  v_add_f32 v7, v24, v26
  v_max_f32 v4, v4, v7
  ds_write_b32 v231, v7 offset:4096
  s_waitcnt vmcnt(5)
  buffer_load_dwordx4 a[32:35], v2, s[28:31], s92 offen offset:0 nt
  s_waitcnt vmcnt(6)
  buffer_load_dwordx4 a[36:39], v2, s[28:31], s92 offen offset:1024 nt
  s_waitcnt vmcnt(6)
  buffer_load_dwordx4 a[40:43], v2, s[28:31], s92 offen offset:2048 nt
  s_waitcnt vmcnt(6)
  buffer_load_dwordx4 a[44:47], v2, s[28:31], s92 offen offset:3072 nt
  s_waitcnt vmcnt(16)
  v_mfma_f32_16x16x32_bf16 v[16:19], a[208:211], v[36:39], 0
  v_mfma_f32_16x16x32_bf16 v[16:19], a[212:215], v[40:43], v[16:19]
  v_mfma_f32_16x16x32_bf16 v[16:19], a[216:219], v[44:47], v[16:19]
  v_mfma_f32_16x16x32_bf16 v[16:19], a[220:223], v[48:51], v[16:19]
  s_add_u32 s66, s3, 65
  s_lshl_b32 s66, s66, 8
  v_add_u32 v231, s66, v230
  s_nop 4
  v_mul_f32_dpp v24, v16, v6 quad_perm:[0,0,0,0] row_mask:0xf bank_mask:0xf
  v_mul_f32_dpp v25, v17, v6 quad_perm:[1,1,1,1] row_mask:0xf bank_mask:0xf
  v_mul_f32_dpp v26, v18, v6 quad_perm:[2,2,2,2] row_mask:0xf bank_mask:0xf
  v_mul_f32_dpp v27, v19, v6 quad_perm:[3,3,3,3] row_mask:0xf bank_mask:0xf
  v_add_f32 v24, v24, v25
  v_add_f32 v26, v26, v27
  v_add_f32 v7, v24, v26
  v_max_f32 v4, v4, v7
  ds_write_b32 v231, v7 offset:4096
  s_waitcnt vmcnt(12)
  v_mfma_f32_16x16x32_bf16 v[16:19], a[48:51], v[36:39], 0
  v_mfma_f32_16x16x32_bf16 v[16:19], a[52:55], v[40:43], v[16:19]
  v_mfma_f32_16x16x32_bf16 v[16:19], a[56:59], v[44:47], v[16:19]
  v_mfma_f32_16x16x32_bf16 v[16:19], a[60:63], v[48:51], v[16:19]
  s_add_u32 s66, s3, 68
  s_lshl_b32 s66, s66, 8
  v_add_u32 v231, s66, v230
  s_add_u32 s91, s3, 80
  s_lshr_b32 s93, s91, 3
  s_lshl_b32 s93, s93, 3
  s_add_u32 s93, s93, s90
  s_lshl_b32 s93, s93, 1
  s_lshl_b32 s94, s63, 1
  s_add_u32 s94, s91, s94
  s_and_b32 s94, s94, 7
  s_lshl_b32 s93, s93, 14
  s_lshl_b32 s94, s94, 12
  s_add_u32 s93, s93, s94
  s_add_u32 s92, s93, s74
  s_lshl_b32 s39, s91, 8
  v_mul_f32_dpp v24, v16, v6 quad_perm:[0,0,0,0] row_mask:0xf bank_mask:0xf
  v_mul_f32_dpp v25, v17, v6 quad_perm:[1,1,1,1] row_mask:0xf bank_mask:0xf
  v_mul_f32_dpp v26, v18, v6 quad_perm:[2,2,2,2] row_mask:0xf bank_mask:0xf
  v_mul_f32_dpp v27, v19, v6 quad_perm:[3,3,3,3] row_mask:0xf bank_mask:0xf
  v_add_f32 v24, v24, v25
  v_add_f32 v26, v26, v27
  v_add_f32 v7, v24, v26
  v_max_f32 v4, v4, v7
  ds_write_b32 v231, v7 offset:4096
  s_waitcnt vmcnt(5)
  buffer_load_dwordx4 a[48:51], v2, s[28:31], s92 offen offset:0 nt
  s_waitcnt vmcnt(6)
  buffer_load_dwordx4 a[52:55], v2, s[28:31], s92 offen offset:1024 nt
  s_waitcnt vmcnt(6)
  buffer_load_dwordx4 a[56:59], v2, s[28:31], s92 offen offset:2048 nt
  s_waitcnt vmcnt(6)
  buffer_load_dwordx4 a[60:63], v2, s[28:31], s92 offen offset:3072 nt
  s_branch L_stream
L_wave0:
  s_and_b32 s66, s60, 7
  s_lshr_b32 s67, s60, 3
  s_lshl_b32 s68, s66, 2
  s_add_u32 s68, s68, s67
  s_lshl_b32 s68, s68, 2
  s_add_u32 s68, s68, s61
  s_mul_i32 s69, s66, 43
  s_add_u32 s72, s69, 43
  s_lshr_b32 s69, s69, 3
  s_lshr_b32 s72, s72, 3
  s_lshl_b32 s66, s61, 2
  s_add_u32 s69, s69, s66
  s_add_u32 s69, s69, s67
  s_sub_u32 s69, s69, 16
  s_sub_u32 s64, s72, s69
  s_mov_b32 s48, 2752
  s_mov_b32 s38, 1409024
  s_cmp_lt_u32 s61, 4
  s_cselect_b32 s64, 1, s64
  s_cselect_b32 s69, s68, s69
  s_cselect_b32 s48, 8192, s48
  s_cselect_b32 s49, 0, 262144
  s_cselect_b32 s50, 0xff800000, 0
  s_cselect_b32 s38, 4194304, s38
  s_cselect_b32 s73, s68, 1
  s_lshl_b32 s66, s69, 7
  s_add_u32 s49, s49, s66
  s_lshl_b32 s51, s69, 6
  s_lshl_b32 s66, s48, 5
  v_lshrrev_b32 v229, 2, v0
  v_mul_lo_u32 v229, v229, s66
  v_and_b32 v237, 3, v0
  v_lshl_add_u32 v229, v237, 4, v229
  v_and_b32 v242, 7, v0
  v_lshlrev_b32 v242, 4, v242
  v_lshl_add_u32 v228, v14, 15, v242
  v_bfe_u32 v243, v0, 3, 1
  v_lshl_add_u32 v228, v243, 11, v228
  s_cmp_lt_u32 s61, 4
  s_waitcnt lgkmcnt(0)
  s_cselect_b32 s36, s10, s16
  s_cselect_b32 s37, s11, s17
  s_mov_b32 s39, 0x00020000
  s_mov_b32 s70, s80
  s_mov_b32 s71, s81
  s_cmp_gt_i32 s64, 0
  s_cbranch_scc1 L_task
  s_barrier
  s_mov_b32 s28, s6
  s_mov_b32 s29, s7
  s_mov_b32 s30, 268435456
  s_mov_b32 s31, 0x00020000
  s_mov_b32 s32, s8
  s_mov_b32 s33, s9
  s_mov_b32 s34, 268435456
  s_mov_b32 s35, 0x00020000
  v_and_b32 v244, 1, v0
  v_lshlrev_b32 v244, 4, v244
  v_mov_b32 v245, 0xffff
  v_lshlrev_b32 v245, v244, v245
  v_and_b32 v246, 2, v0
  v_cmp_eq_u32 vcc, 0, v246
  v_bfe_u32 v246, v0, 1, 2
  s_nop 0
  v_cndmask_b32 v9, 0, v245, vcc
  v_cndmask_b32 v10, v245, 0, vcc
  v_cmp_eq_u32 vcc, 0, v246
  s_nop 1
  v_cndmask_b32 v20, 0, v245, vcc
  v_cmp_eq_u32 vcc, 1, v246
  s_nop 1
  v_cndmask_b32 v21, 0, v245, vcc
  v_cmp_eq_u32 vcc, 2, v246
  s_nop 1
  v_cndmask_b32 v22, 0, v245, vcc
  v_cmp_eq_u32 vcc, 3, v246
  s_nop 1
  v_cndmask_b32 v23, 0, v245, vcc
  v_mov_b32 v6, 0x3e0293ee
  v_mov_b32 v4, 0xff61b1e6
  v_mov_b32 v220, 0
  v_mov_b32 v221, 0
  v_mov_b32 v222, 0
  v_mov_b32 v223, 0
  v_mov_b32 v224, 0x3f803f80
  v_mov_b32 v225, 0x3f803f80
  v_mov_b32 v52, 0
  v_mov_b32 v53, 0
  v_mov_b32 v54, 0
  v_mov_b32 v55, 0
  v_mov_b32 v56, 0
  v_mov_b32 v57, 0
  v_mov_b32 v58, 0
  v_mov_b32 v59, 0
  v_mov_b32 v60, 0
  v_mov_b32 v61, 0
  v_mov_b32 v62, 0
  v_mov_b32 v63, 0
  v_mov_b32 v64, 0
  v_mov_b32 v65, 0
  v_mov_b32 v66, 0
  v_mov_b32 v67, 0
  v_mov_b32 v68, 0
  v_mov_b32 v69, 0
  v_mov_b32 v70, 0
  v_mov_b32 v71, 0
  v_mov_b32 v72, 0
  v_mov_b32 v73, 0
  v_mov_b32 v74, 0
  v_mov_b32 v75, 0
  v_mov_b32 v76, 0
  v_mov_b32 v77, 0
  v_mov_b32 v78, 0
  v_mov_b32 v79, 0
  v_mov_b32 v80, 0
  v_mov_b32 v81, 0
  v_mov_b32 v82, 0
  v_mov_b32 v83, 0
  v_mov_b32 v227, 1
  v_lshlrev_b32 v230, 2, v0
  v_lshlrev_b32 v11, 6, v15
  v_and_b32 v244, 1, v14
  v_lshl_add_u32 v11, v244, 5, v11
  v_lshrrev_b32 v244, 1, v14
  v_lshl_add_u32 v11, v244, 4, v11
  s_mov_b32 s56, s24
  s_mov_b32 s57, s25
  s_mov_b32 s58, 1769472
  s_mov_b32 s59, 0x00020000
  s_mov_b32 s44, s4
  s_mov_b32 s45, s5
  s_mov_b32 s46, 1024
  s_mov_b32 s47, 0x00020000
  s_mov_b32 s88, 0x7fffffff
  s_lshl_b32 s75, s60, 3
  s_add_u32 s75, s75, s61
  s_lshl_b32 s66, s60, 8
  s_add_u32 s66, s66, 983040
  s_add_u32 s86, s24, s66
  s_addc_u32 s87, s25, 0
  buffer_load_dword v180, v1, s[32:35], s74 offen nt
  s_waitcnt vmcnt(0)
  s_load_dwordx2 s[80:81], s[22:23], 0x0
  s_waitcnt lgkmcnt(0)
  s_or_b32 s66, s80, s81
  s_cmp_lg_u32 s66, 0
  s_cbranch_scc1 L_haveep0
  s_mov_b32 s80, s70
  s_mov_b32 s81, s71
  s_mov_b32 s82, 0
  s_mov_b32 s83, 0
  s_atomic_cmpswap_x2 s[80:83], s[22:23], 0x0 glc
  s_waitcnt lgkmcnt(0)
  s_or_b32 s66, s80, s81
  s_cmp_eq_u32 s66, 0
  s_cselect_b32 s80, s70, s80
  s_cselect_b32 s81, s71, s81
L_haveep0:
  s_branch L_join
L_task:
  s_mov_b32 s44, s4
  s_mov_b32 s45, s5
  s_mov_b32 s46, 1024
  s_mov_b32 s47, 0x00020000
  buffer_load_dwordx4 v[232:235], v3, s[44:47], 0 offen
  buffer_load_dwordx4 a[128:131], v229, s[36:39], s51 offen nt
  s_add_u32 s51, s51, s48
  buffer_load_dwordx4 a[132:135], v229, s[36:39], s51 offen nt
  s_add_u32 s51, s51, s48
  buffer_load_dwordx4 a[136:139], v229, s[36:39], s51 offen nt
  s_add_u32 s51, s51, s48
  buffer_load_dwordx4 a[140:143], v229, s[36:39], s51 offen nt
  s_add_u32 s51, s51, s48
  s_mov_b32 s82, 0
  s_mov_b32 s83, 0
  s_cmp_ge_u32 s2, 8
  s_cbranch_scc1 L_nocas0
  s_atomic_cmpswap_x2 s[80:83], s[22:23], 0x0 glc
L_nocas0:
  s_barrier
  buffer_load_dwordx4 a[144:147], v229, s[36:39], s51 offen nt
  s_add_u32 s51, s51, s48
  buffer_load_dwordx4 a[148:151], v229, s[36:39], s51 offen nt
  s_add_u32 s51, s51, s48
  buffer_load_dwordx4 a[152:155], v229, s[36:39], s51 offen nt
  s_add_u32 s51, s51, s48
  buffer_load_dwordx4 a[156:159], v229, s[36:39], s51 offen nt
  s_add_u32 s51, s51, s48
  buffer_load_dwordx4 a[160:163], v229, s[36:39], s51 offen nt
  s_add_u32 s51, s51, s48
  buffer_load_dwordx4 a[164:167], v229, s[36:39], s51 offen nt
  s_add_u32 s51, s51, s48
  buffer_load_dwordx4 a[168:171], v229, s[36:39], s51 offen nt
  s_add_u32 s51, s51, s48
  buffer_load_dwordx4 a[172:175], v229, s[36:39], s51 offen nt
  s_add_u32 s51, s51, s48
  buffer_load_dwordx4 a[176:179], v229, s[36:39], s51 offen nt
  s_add_u32 s51, s51, s48
  buffer_load_dwordx4 a[180:183], v229, s[36:39], s51 offen nt
  s_add_u32 s51, s51, s48
  buffer_load_dwordx4 a[184:187], v229, s[36:39], s51 offen nt
  s_add_u32 s51, s51, s48
  buffer_load_dwordx4 a[188:191], v229, s[36:39], s51 offen nt
  s_add_u32 s51, s51, s48
  buffer_load_dwordx4 a[192:195], v229, s[36:39], s51 offen nt
  s_add_u32 s51, s51, s48
  buffer_load_dwordx4 a[196:199], v229, s[36:39], s51 offen nt
  s_add_u32 s51, s51, s48
  buffer_load_dwordx4 a[200:203], v229, s[36:39], s51 offen nt
  s_add_u32 s51, s51, s48
  buffer_load_dwordx4 a[204:207], v229, s[36:39], s51 offen nt
  s_add_u32 s51, s51, s48
  buffer_load_dwordx4 a[208:211], v229, s[36:39], s51 offen nt
  s_add_u32 s51, s51, s48
  buffer_load_dwordx4 a[212:215], v229, s[36:39], s51 offen nt
  s_add_u32 s51, s51, s48
  buffer_load_dwordx4 a[216:219], v229, s[36:39], s51 offen nt
  s_add_u32 s51, s51, s48
  buffer_load_dwordx4 a[220:223], v229, s[36:39], s51 offen nt
  s_add_u32 s51, s51, s48
  buffer_load_dwordx4 a[224:227], v229, s[36:39], s51 offen nt
  s_add_u32 s51, s51, s48
  buffer_load_dwordx4 a[228:231], v229, s[36:39], s51 offen nt
  s_add_u32 s51, s51, s48
  buffer_load_dwordx4 a[232:235], v229, s[36:39], s51 offen nt
  s_add_u32 s51, s51, s48
  buffer_load_dwordx4 a[236:239], v229, s[36:39], s51 offen nt
  s_add_u32 s51, s51, s48
  buffer_load_dwordx4 a[240:243], v229, s[36:39], s51 offen nt
  s_add_u32 s51, s51, s48
  buffer_load_dwordx4 a[244:247], v229, s[36:39], s51 offen nt
  s_add_u32 s51, s51, s48
  buffer_load_dwordx4 a[248:251], v229, s[36:39], s51 offen nt
  s_add_u32 s51, s51, s48
  buffer_load_dwordx4 a[252:255], v229, s[36:39], s51 offen nt
  s_and_b32 s66, s73, 3
  s_cmp_lg_u32 s66, 0
  s_cbranch_scc1 L_notk
  s_lshl_b32 s66, s73, 6
  s_add_u32 s66, s66, 983040
  s_add_u32 s86, s24, s66
  s_addc_u32 s87, s25, 0
  s_mov_b32 s84, 0
  s_atomic_swap s84, s[86:87], 0x0 glc
L_notk:
  s_mov_b32 s28, s6
  s_mov_b32 s29, s7
  s_mov_b32 s30, 268435456
  s_mov_b32 s31, 0x00020000
  s_mov_b32 s32, s8
  s_mov_b32 s33, s9
  s_mov_b32 s34, 268435456
  s_mov_b32 s35, 0x00020000
  v_and_b32 v244, 1, v0
  v_lshlrev_b32 v244, 4, v244
  v_mov_b32 v245, 0xffff
  v_lshlrev_b32 v245, v244, v245
  v_and_b32 v246, 2, v0
  v_cmp_eq_u32 vcc, 0, v246
  v_bfe_u32 v246, v0, 1, 2
  s_nop 0
  v_cndmask_b32 v9, 0, v245, vcc
  v_cndmask_b32 v10, v245, 0, vcc
  v_cmp_eq_u32 vcc, 0, v246
  s_nop 1
  v_cndmask_b32 v20, 0, v245, vcc
  v_cmp_eq_u32 vcc, 1, v246
  s_nop 1
  v_cndmask_b32 v21, 0, v245, vcc
  v_cmp_eq_u32 vcc, 2, v246
  s_nop 1
  v_cndmask_b32 v22, 0, v245, vcc
  v_cmp_eq_u32 vcc, 3, v246
  s_nop 1
  v_cndmask_b32 v23, 0, v245, vcc
  v_mov_b32 v6, 0x3e0293ee
  v_mov_b32 v4, 0xff61b1e6
  v_mov_b32 v220, 0
  v_mov_b32 v221, 0
  v_mov_b32 v222, 0
  v_mov_b32 v223, 0
  v_mov_b32 v224, 0x3f803f80
  v_mov_b32 v225, 0x3f803f80
  v_mov_b32 v52, 0
  v_mov_b32 v53, 0
  v_mov_b32 v54, 0
  v_mov_b32 v55, 0
  v_mov_b32 v56, 0
  v_mov_b32 v57, 0
  v_mov_b32 v58, 0
  v_mov_b32 v59, 0
  v_mov_b32 v60, 0
  v_mov_b32 v61, 0
  v_mov_b32 v62, 0
  v_mov_b32 v63, 0
  v_mov_b32 v64, 0
  v_mov_b32 v65, 0
  v_mov_b32 v66, 0
  v_mov_b32 v67, 0
  v_mov_b32 v68, 0
  v_mov_b32 v69, 0
  v_mov_b32 v70, 0
  v_mov_b32 v71, 0
  v_mov_b32 v72, 0
  v_mov_b32 v73, 0
  v_mov_b32 v74, 0
  v_mov_b32 v75, 0
  v_mov_b32 v76, 0
  v_mov_b32 v77, 0
  v_mov_b32 v78, 0
  v_mov_b32 v79, 0
  v_mov_b32 v80, 0
  v_mov_b32 v81, 0
  v_mov_b32 v82, 0
  v_mov_b32 v83, 0
  v_mov_b32 v227, 1
  v_lshlrev_b32 v230, 2, v0
  v_lshlrev_b32 v11, 6, v15
  v_and_b32 v244, 1, v14
  v_lshl_add_u32 v11, v244, 5, v11
  v_lshrrev_b32 v244, 1, v14
  v_lshl_add_u32 v11, v244, 4, v11
  s_mov_b32 s56, s24
  s_mov_b32 s57, s25
  s_mov_b32 s58, 1769472
  s_mov_b32 s59, 0x00020000
  s_mov_b32 s44, s4
  s_mov_b32 s45, s5
  s_mov_b32 s46, 1024
  s_mov_b32 s47, 0x00020000
  s_mov_b32 s88, 0x7fffffff
  s_lshl_b32 s75, s60, 3
  s_add_u32 s75, s75, s61
  s_lshl_b32 s66, s60, 8
  s_add_u32 s66, s66, 983040
  s_add_u32 s86, s24, s66
  s_addc_u32 s87, s25, 0
  s_waitcnt vmcnt(32)
  v_lshlrev_b32 v172, 16, v232
  v_and_b32 v173, 0xffff0000, v232
  v_lshlrev_b32 v174, 16, v233
  v_and_b32 v175, 0xffff0000, v233
  v_lshlrev_b32 v176, 16, v234
  v_and_b32 v177, 0xffff0000, v234
  v_lshlrev_b32 v178, 16, v235
  v_and_b32 v179, 0xffff0000, v235
  v_add_f32 v244, v172, v173
  v_add_f32 v244, v244, v174
  v_add_f32 v244, v244, v175
  v_add_f32 v244, v244, v176
  v_add_f32 v244, v244, v177
  v_add_f32 v244, v244, v178
  v_add_f32 v244, v244, v179
  s_nop 1
  v_add_f32_dpp v244, v244, v244 quad_perm:[1,0,3,2] row_mask:0xf bank_mask:0xf
  s_nop 1
  v_add_f32_dpp v244, v244, v244 quad_perm:[2,3,0,1] row_mask:0xf bank_mask:0xf
  s_nop 1
  v_add_f32_dpp v244, v244, v244 row_half_mirror row_mask:0xf bank_mask:0xf
  s_nop 1
  v_add_f32_dpp v244, v244, v244 row_mirror row_mask:0xf bank_mask:0xf
  s_nop 0
  v_readlane_b32 s96, v244, 0
  v_readlane_b32 s97, v244, 16
  v_readlane_b32 s98, v244, 32
  v_readlane_b32 s99, v244, 48
  s_nop 1
  v_mov_b32 v244, s96
  v_add_f32 v244, s97, v244
  v_add_f32 v244, s98, v244
  v_add_f32 v244, s99, v244
  v_mul_f32 v244, 0x3b000000, v244
  v_mov_b32 v245, 0
  v_sub_f32 v236, v172, v244
  v_fmac_f32 v245, v236, v236
  v_sub_f32 v237, v173, v244
  v_fmac_f32 v245, v237, v237
  v_sub_f32 v238, v174, v244
  v_fmac_f32 v245, v238, v238
  v_sub_f32 v239, v175, v244
  v_fmac_f32 v245, v239, v239
  v_sub_f32 v240, v176, v244
  v_fmac_f32 v245, v240, v240
  v_sub_f32 v241, v177, v244
  v_fmac_f32 v245, v241, v241
  v_sub_f32 v242, v178, v244
  v_fmac_f32 v245, v242, v242
  v_sub_f32 v243, v179, v244
  v_fmac_f32 v245, v243, v243
  s_nop 1
  v_add_f32_dpp v245, v245, v245 quad_perm:[1,0,3,2] row_mask:0xf bank_mask:0xf
  s_nop 1
  v_add_f32_dpp v245, v245, v245 quad_perm:[2,3,0,1] row_mask:0xf bank_mask:0xf
  s_nop 1
  v_add_f32_dpp v245, v245, v245 row_half_mirror row_mask:0xf bank_mask:0xf
  s_nop 1
  v_add_f32_dpp v245, v245, v245 row_mirror row_mask:0xf bank_mask:0xf
  s_nop 0
  v_readlane_b32 s96, v245, 0
  v_readlane_b32 s97, v245, 16
  v_readlane_b32 s98, v245, 32
  v_readlane_b32 s99, v245, 48
  s_nop 1
  v_mov_b32 v245, s96
  v_add_f32 v245, s97, v245
  v_add_f32 v245, s98, v245
  v_add_f32 v245, s99, v245
  v_mul_f32 v245, 0x3b000000, v245
  v_cvt_pk_bf16_f32 v244, v244, v244
  v_and_b32 v244, 0xffff0000, v244
  v_cvt_pk_bf16_f32 v245, v245, v245
  v_and_b32 v245, 0xffff0000, v245
  v_add_f32 v245, 0x3727c5ac, v245
  v_cvt_pk_bf16_f32 v245, v245, v245
  v_and_b32 v245, 0xffff0000, v245
  v_sqrt_f32 v245, v245
  s_nop 0
  v_cvt_pk_bf16_f32 v245, v245, v245
  v_and_b32 v245, 0xffff0000, v245
  v_rcp_f32 v245, v245
  v_sub_f32 v172, v172, v244
  v_sub_f32 v173, v173, v244
  v_sub_f32 v174, v174, v244
  v_sub_f32 v175, v175, v244
  v_sub_f32 v176, v176, v244
  v_sub_f32 v177, v177, v244
  v_sub_f32 v178, v178, v244
  v_sub_f32 v179, v179, v244
  v_cvt_pk_bf16_f32 v172, v172, v172
  v_and_b32 v172, 0xffff0000, v172
  v_cvt_pk_bf16_f32 v173, v173, v173
  v_and_b32 v173, 0xffff0000, v173
  v_cvt_pk_bf16_f32 v174, v174, v174
  v_and_b32 v174, 0xffff0000, v174
  v_cvt_pk_bf16_f32 v175, v175, v175
  v_and_b32 v175, 0xffff0000, v175
  v_cvt_pk_bf16_f32 v176, v176, v176
  v_and_b32 v176, 0xffff0000, v176
  v_cvt_pk_bf16_f32 v177, v177, v177
  v_and_b32 v177, 0xffff0000, v177
  v_cvt_pk_bf16_f32 v178, v178, v178
  v_and_b32 v178, 0xffff0000, v178
  v_cvt_pk_bf16_f32 v179, v179, v179
  v_and_b32 v179, 0xffff0000, v179
  v_mul_f32 v172, v172, v245
  v_mul_f32 v173, v173, v245
  v_mul_f32 v174, v174, v245
  v_mul_f32 v175, v175, v245
  v_mul_f32 v176, v176, v245
  v_mul_f32 v177, v177, v245
  v_mul_f32 v178, v178, v245
  v_mul_f32 v179, v179, v245
  v_cvt_pk_bf16_f32 v172, v172, v172
  v_cvt_pk_bf16_f32 v173, v173, v173
  v_cvt_pk_bf16_f32 v174, v174, v174
  v_cvt_pk_bf16_f32 v175, v175, v175
  v_cvt_pk_bf16_f32 v176, v176, v176
  v_cvt_pk_bf16_f32 v177, v177, v177
  v_cvt_pk_bf16_f32 v178, v178, v178
  v_cvt_pk_bf16_f32 v179, v179, v179
  s_waitcnt lgkmcnt(0)
  s_load_dwordx2 s[80:81], s[22:23], 0x0
  v_and_b32_dpp v24, v172, v9 quad_perm:[0,0,0,0] row_mask:0xf bank_mask:0xf
  v_and_b32_dpp v25, v172, v10 quad_perm:[0,0,0,0] row_mask:0xf bank_mask:0xf
  v_and_b32_dpp v26, v173, v9 quad_perm:[0,0,0,0] row_mask:0xf bank_mask:0xf
  v_and_b32_dpp v27, v173, v10 quad_perm:[0,0,0,0] row_mask:0xf bank_mask:0xf
  s_waitcnt vmcnt(28)
  v_mfma_f32_16x16x16_bf16 v[16:19], v[24:25], a[128:129], 0
  v_mfma_f32_16x16x16_bf16 v[32:35], v[24:25], a[130:131], 0
  v_and_b32_dpp v24, v174, v9 quad_perm:[0,0,0,0] row_mask:0xf bank_mask:0xf
  v_and_b32_dpp v25, v174, v10 quad_perm:[0,0,0,0] row_mask:0xf bank_mask:0xf
  v_mfma_f32_16x16x16_bf16 v[16:19], v[26:27], a[132:133], v[16:19]
  v_mfma_f32_16x16x16_bf16 v[32:35], v[26:27], a[134:135], v[32:35]
  v_and_b32_dpp v26, v175, v9 quad_perm:[0,0,0,0] row_mask:0xf bank_mask:0xf
  v_and_b32_dpp v27, v175, v10 quad_perm:[0,0,0,0] row_mask:0xf bank_mask:0xf
  v_mfma_f32_16x16x16_bf16 v[16:19], v[24:25], a[136:137], v[16:19]
  v_mfma_f32_16x16x16_bf16 v[32:35], v[24:25], a[138:139], v[32:35]
  v_and_b32_dpp v24, v176, v9 quad_perm:[0,0,0,0] row_mask:0xf bank_mask:0xf
  v_and_b32_dpp v25, v176, v10 quad_perm:[0,0,0,0] row_mask:0xf bank_mask:0xf
  v_mfma_f32_16x16x16_bf16 v[16:19], v[26:27], a[140:141], v[16:19]
  v_mfma_f32_16x16x16_bf16 v[32:35], v[26:27], a[142:143], v[32:35]
  v_and_b32_dpp v26, v177, v9 quad_perm:[0,0,0,0] row_mask:0xf bank_mask:0xf
  v_and_b32_dpp v27, v177, v10 quad_perm:[0,0,0,0] row_mask:0xf bank_mask:0xf
  s_waitcnt vmcnt(24)
  v_mfma_f32_16x16x16_bf16 v[16:19], v[24:25], a[144:145], v[16:19]
  v_mfma_f32_16x16x16_bf16 v[32:35], v[24:25], a[146:147], v[32:35]
  v_and_b32_dpp v24, v178, v9 quad_perm:[0,0,0,0] row_mask:0xf bank_mask:0xf
  v_and_b32_dpp v25, v178, v10 quad_perm:[0,0,0,0] row_mask:0xf bank_mask:0xf
  v_mfma_f32_16x16x16_bf16 v[16:19], v[26:27], a[148:149], v[16:19]
  v_mfma_f32_16x16x16_bf16 v[32:35], v[26:27], a[150:151], v[32:35]
  v_and_b32_dpp v26, v179, v9 quad_perm:[0,0,0,0] row_mask:0xf bank_mask:0xf
  v_and_b32_dpp v27, v179, v10 quad_perm:[0,0,0,0] row_mask:0xf bank_mask:0xf
  v_mfma_f32_16x16x16_bf16 v[16:19], v[24:25], a[152:153], v[16:19]
  v_mfma_f32_16x16x16_bf16 v[32:35], v[24:25], a[154:155], v[32:35]
  v_and_b32_dpp v24, v172, v9 quad_perm:[1,1,1,1] row_mask:0xf bank_mask:0xf
  v_and_b32_dpp v25, v172, v10 quad_perm:[1,1,1,1] row_mask:0xf bank_mask:0xf
  v_mfma_f32_16x16x16_bf16 v[16:19], v[26:27], a[156:157], v[16:19]
  v_mfma_f32_16x16x16_bf16 v[32:35], v[26:27], a[158:159], v[32:35]
  v_and_b32_dpp v26, v173, v9 quad_perm:[1,1,1,1] row_mask:0xf bank_mask:0xf
  v_and_b32_dpp v27, v173, v10 quad_perm:[1,1,1,1] row_mask:0xf bank_mask:0xf
  s_waitcnt vmcnt(20)
  v_mfma_f32_16x16x16_bf16 v[16:19], v[24:25], a[160:161], v[16:19]
  v_mfma_f32_16x16x16_bf16 v[32:35], v[24:25], a[162:163], v[32:35]
  v_and_b32_dpp v24, v174, v9 quad_perm:[1,1,1,1] row_mask:0xf bank_mask:0xf
  v_and_b32_dpp v25, v174, v10 quad_perm:[1,1,1,1] row_mask:0xf bank_mask:0xf
  v_mfma_f32_16x16x16_bf16 v[16:19], v[26:27], a[164:165], v[16:19]
  v_mfma_f32_16x16x16_bf16 v[32:35], v[26:27], a[166:167], v[32:35]
  v_and_b32_dpp v26, v175, v9 quad_perm:[1,1,1,1] row_mask:0xf bank_mask:0xf
  v_and_b32_dpp v27, v175, v10 quad_perm:[1,1,1,1] row_mask:0xf bank_mask:0xf
  v_mfma_f32_16x16x16_bf16 v[16:19], v[24:25], a[168:169], v[16:19]
  v_mfma_f32_16x16x16_bf16 v[32:35], v[24:25], a[170:171], v[32:35]
  v_and_b32_dpp v24, v176, v9 quad_perm:[1,1,1,1] row_mask:0xf bank_mask:0xf
  v_and_b32_dpp v25, v176, v10 quad_perm:[1,1,1,1] row_mask:0xf bank_mask:0xf
  v_mfma_f32_16x16x16_bf16 v[16:19], v[26:27], a[172:173], v[16:19]
  v_mfma_f32_16x16x16_bf16 v[32:35], v[26:27], a[174:175], v[32:35]
  v_and_b32_dpp v26, v177, v9 quad_perm:[1,1,1,1] row_mask:0xf bank_mask:0xf
  v_and_b32_dpp v27, v177, v10 quad_perm:[1,1,1,1] row_mask:0xf bank_mask:0xf
  s_waitcnt vmcnt(16)
  v_mfma_f32_16x16x16_bf16 v[16:19], v[24:25], a[176:177], v[16:19]
  v_mfma_f32_16x16x16_bf16 v[32:35], v[24:25], a[178:179], v[32:35]
  v_and_b32_dpp v24, v178, v9 quad_perm:[1,1,1,1] row_mask:0xf bank_mask:0xf
  v_and_b32_dpp v25, v178, v10 quad_perm:[1,1,1,1] row_mask:0xf bank_mask:0xf
  v_mfma_f32_16x16x16_bf16 v[16:19], v[26:27], a[180:181], v[16:19]
  v_mfma_f32_16x16x16_bf16 v[32:35], v[26:27], a[182:183], v[32:35]
  v_and_b32_dpp v26, v179, v9 quad_perm:[1,1,1,1] row_mask:0xf bank_mask:0xf
  v_and_b32_dpp v27, v179, v10 quad_perm:[1,1,1,1] row_mask:0xf bank_mask:0xf
  v_mfma_f32_16x16x16_bf16 v[16:19], v[24:25], a[184:185], v[16:19]
  v_mfma_f32_16x16x16_bf16 v[32:35], v[24:25], a[186:187], v[32:35]
  v_and_b32_dpp v24, v172, v9 quad_perm:[2,2,2,2] row_mask:0xf bank_mask:0xf
  v_and_b32_dpp v25, v172, v10 quad_perm:[2,2,2,2] row_mask:0xf bank_mask:0xf
  v_mfma_f32_16x16x16_bf16 v[16:19], v[26:27], a[188:189], v[16:19]
  v_mfma_f32_16x16x16_bf16 v[32:35], v[26:27], a[190:191], v[32:35]
  v_and_b32_dpp v26, v173, v9 quad_perm:[2,2,2,2] row_mask:0xf bank_mask:0xf
  v_and_b32_dpp v27, v173, v10 quad_perm:[2,2,2,2] row_mask:0xf bank_mask:0xf
  s_waitcnt vmcnt(12)
  v_mfma_f32_16x16x16_bf16 v[16:19], v[24:25], a[192:193], v[16:19]
  v_mfma_f32_16x16x16_bf16 v[32:35], v[24:25], a[194:195], v[32:35]
  v_and_b32_dpp v24, v174, v9 quad_perm:[2,2,2,2] row_mask:0xf bank_mask:0xf
  v_and_b32_dpp v25, v174, v10 quad_perm:[2,2,2,2] row_mask:0xf bank_mask:0xf
  v_mfma_f32_16x16x16_bf16 v[16:19], v[26:27], a[196:197], v[16:19]
  v_mfma_f32_16x16x16_bf16 v[32:35], v[26:27], a[198:199], v[32:35]
  v_and_b32_dpp v26, v175, v9 quad_perm:[2,2,2,2] row_mask:0xf bank_mask:0xf
  v_and_b32_dpp v27, v175, v10 quad_perm:[2,2,2,2] row_mask:0xf bank_mask:0xf
  v_mfma_f32_16x16x16_bf16 v[16:19], v[24:25], a[200:201], v[16:19]
  v_mfma_f32_16x16x16_bf16 v[32:35], v[24:25], a[202:203], v[32:35]
  v_and_b32_dpp v24, v176, v9 quad_perm:[2,2,2,2] row_mask:0xf bank_mask:0xf
  v_and_b32_dpp v25, v176, v10 quad_perm:[2,2,2,2] row_mask:0xf bank_mask:0xf
  v_mfma_f32_16x16x16_bf16 v[16:19], v[26:27], a[204:205], v[16:19]
  v_mfma_f32_16x16x16_bf16 v[32:35], v[26:27], a[206:207], v[32:35]
  v_and_b32_dpp v26, v177, v9 quad_perm:[2,2,2,2] row_mask:0xf bank_mask:0xf
  v_and_b32_dpp v27, v177, v10 quad_perm:[2,2,2,2] row_mask:0xf bank_mask:0xf
  s_waitcnt vmcnt(8)
  v_mfma_f32_16x16x16_bf16 v[16:19], v[24:25], a[208:209], v[16:19]
  v_mfma_f32_16x16x16_bf16 v[32:35], v[24:25], a[210:211], v[32:35]
  v_and_b32_dpp v24, v178, v9 quad_perm:[2,2,2,2] row_mask:0xf bank_mask:0xf
  v_and_b32_dpp v25, v178, v10 quad_perm:[2,2,2,2] row_mask:0xf bank_mask:0xf
  v_mfma_f32_16x16x16_bf16 v[16:19], v[26:27], a[212:213], v[16:19]
  v_mfma_f32_16x16x16_bf16 v[32:35], v[26:27], a[214:215], v[32:35]
  v_and_b32_dpp v26, v179, v9 quad_perm:[2,2,2,2] row_mask:0xf bank_mask:0xf
  v_and_b32_dpp v27, v179, v10 quad_perm:[2,2,2,2] row_mask:0xf bank_mask:0xf
  v_mfma_f32_16x16x16_bf16 v[16:19], v[24:25], a[216:217], v[16:19]
  v_mfma_f32_16x16x16_bf16 v[32:35], v[24:25], a[218:219], v[32:35]
  v_and_b32_dpp v24, v172, v9 quad_perm:[3,3,3,3] row_mask:0xf bank_mask:0xf
  v_and_b32_dpp v25, v172, v10 quad_perm:[3,3,3,3] row_mask:0xf bank_mask:0xf
  v_mfma_f32_16x16x16_bf16 v[16:19], v[26:27], a[220:221], v[16:19]
  v_mfma_f32_16x16x16_bf16 v[32:35], v[26:27], a[222:223], v[32:35]
  v_and_b32_dpp v26, v173, v9 quad_perm:[3,3,3,3] row_mask:0xf bank_mask:0xf
  v_and_b32_dpp v27, v173, v10 quad_perm:[3,3,3,3] row_mask:0xf bank_mask:0xf
  s_waitcnt vmcnt(4)
  v_mfma_f32_16x16x16_bf16 v[16:19], v[24:25], a[224:225], v[16:19]
  v_mfma_f32_16x16x16_bf16 v[32:35], v[24:25], a[226:227], v[32:35]
  v_and_b32_dpp v24, v174, v9 quad_perm:[3,3,3,3] row_mask:0xf bank_mask:0xf
  v_and_b32_dpp v25, v174, v10 quad_perm:[3,3,3,3] row_mask:0xf bank_mask:0xf
  v_mfma_f32_16x16x16_bf16 v[16:19], v[26:27], a[228:229], v[16:19]
  v_mfma_f32_16x16x16_bf16 v[32:35], v[26:27], a[230:231], v[32:35]
  v_and_b32_dpp v26, v175, v9 quad_perm:[3,3,3,3] row_mask:0xf bank_mask:0xf
  v_and_b32_dpp v27, v175, v10 quad_perm:[3,3,3,3] row_mask:0xf bank_mask:0xf
  v_mfma_f32_16x16x16_bf16 v[16:19], v[24:25], a[232:233], v[16:19]
  v_mfma_f32_16x16x16_bf16 v[32:35], v[24:25], a[234:235], v[32:35]
  v_and_b32_dpp v24, v176, v9 quad_perm:[3,3,3,3] row_mask:0xf bank_mask:0xf
  v_and_b32_dpp v25, v176, v10 quad_perm:[3,3,3,3] row_mask:0xf bank_mask:0xf
  v_mfma_f32_16x16x16_bf16 v[16:19], v[26:27], a[236:237], v[16:19]
  v_mfma_f32_16x16x16_bf16 v[32:35], v[26:27], a[238:239], v[32:35]
  v_and_b32_dpp v26, v177, v9 quad_perm:[3,3,3,3] row_mask:0xf bank_mask:0xf
  v_and_b32_dpp v27, v177, v10 quad_perm:[3,3,3,3] row_mask:0xf bank_mask:0xf
  s_waitcnt vmcnt(0)
  v_mfma_f32_16x16x16_bf16 v[16:19], v[24:25], a[240:241], v[16:19]
  v_mfma_f32_16x16x16_bf16 v[32:35], v[24:25], a[242:243], v[32:35]
  v_and_b32_dpp v24, v178, v9 quad_perm:[3,3,3,3] row_mask:0xf bank_mask:0xf
  v_and_b32_dpp v25, v178, v10 quad_perm:[3,3,3,3] row_mask:0xf bank_mask:0xf
  v_mfma_f32_16x16x16_bf16 v[16:19], v[26:27], a[244:245], v[16:19]
  v_mfma_f32_16x16x16_bf16 v[32:35], v[26:27], a[246:247], v[32:35]
  v_and_b32_dpp v26, v179, v9 quad_perm:[3,3,3,3] row_mask:0xf bank_mask:0xf
  v_and_b32_dpp v27, v179, v10 quad_perm:[3,3,3,3] row_mask:0xf bank_mask:0xf
  v_mfma_f32_16x16x16_bf16 v[16:19], v[24:25], a[248:249], v[16:19]
  v_mfma_f32_16x16x16_bf16 v[32:35], v[24:25], a[250:251], v[32:35]
  v_mfma_f32_16x16x16_bf16 v[16:19], v[26:27], a[252:253], v[16:19]
  v_mfma_f32_16x16x16_bf16 v[32:35], v[26:27], a[254:255], v[32:35]
  v_and_b32 v236, 3, v0
  v_lshlrev_b32 v236, 5, v236
  v_lshl_add_u32 v236, v14, 7, v236
  v_and_b32 v237, 7, v0
  v_lshlrev_b32 v237, 4, v237
  s_waitcnt lgkmcnt(0)
  s_or_b32 s66, s80, s81
  s_cmp_lg_u32 s66, 0
  s_cbranch_scc1 L_haveep1
  s_mov_b32 s80, s70
  s_mov_b32 s81, s71
  s_mov_b32 s82, 0
  s_mov_b32 s83, 0
  s_atomic_cmpswap_x2 s[80:83], s[22:23], 0x0 glc
  s_waitcnt lgkmcnt(0)
  s_or_b32 s66, s80, s81
  s_cmp_eq_u32 s66, 0
  s_cselect_b32 s80, s70, s80
  s_cselect_b32 s81, s71, s81
L_haveep1:
  s_mov_b32 exec_lo, 0x00f0000f
  s_mov_b32 exec_hi, 0xf0000f00
  ds_write_b128 v236, v[16:19] offset:1024
  ds_write_b128 v236, v[32:35] offset:1040
  s_mov_b64 exec, -1
  ds_read_b128 v[172:175], v237 offset:1024
  ds_read_b128 v[176:179], v237 offset:1152
  ds_read_b128 v[180:183], v237 offset:1280
  ds_read_b128 v[184:187], v237 offset:1408
  v_mov_b32 v25, s80
  v_mov_b32 v27, s81
  s_waitcnt lgkmcnt(0)
  v_add_f32 v172, v172, v176
  v_add_f32 v180, v180, v184
  v_add_f32 v173, v173, v177
  v_add_f32 v181, v181, v185
  v_add_f32 v174, v174, v178
  v_add_f32 v182, v182, v186
  v_add_f32 v175, v175, v179
  v_add_f32 v183, v183, v187
  v_add_f32 v172, v172, v180
  v_add_f32 v173, v173, v181
  v_add_f32 v174, v174, v182
  v_add_f32 v175, v175, v183
  v_max_f32 v172, s50, v172
  v_max_f32 v173, s50, v173
  v_max_f32 v174, s50, v174
  v_max_f32 v175, s50, v175
  v_cvt_pk_bf16_f32 v24, v172, v173
  v_cvt_pk_bf16_f32 v26, v174, v175
  s_mov_b64 exec, 0xff
  buffer_store_dwordx4 v[24:27], v3, s[56:59], s49 offen sc1
  s_mov_b64 exec, -1
L_join:
  s_mov_b32 s40, s12
  s_mov_b32 s41, s13
  s_mov_b32 s42, 4194304
  s_mov_b32 s43, 0x00020000
  s_mov_b32 s52, s18
  s_mov_b32 s53, s19
  s_mov_b32 s54, 1409024
  s_mov_b32 s55, 0x00020000
  s_lshl_b32 s66, s60, 17
  s_mul_i32 s67, s60, 40960
  s_mov_b64 exec, 1
  buffer_load_dword v180, v1, s[40:43], s66 offen nt
  buffer_load_dword v181, v1, s[52:55], s67 offen nt
  s_mov_b64 exec, -1
  s_lshl_b32 s66, s60, 9
  s_mov_b32 exec_hi, 0
  s_mov_b32 s73, 400000
L_poll_q:
  buffer_load_dwordx4 v[172:175], v3, s[56:59], s66 offen sc1
  s_sub_u32 s73, s73, 1
  s_waitcnt vmcnt(0)
  v_xor_b32 v244, s80, v173
  v_xor_b32 v245, s81, v175
  v_or_b32 v246, v244, v245
  v_cmp_ne_u32 vcc, 0, v246
  s_cbranch_vccz L_polld_q
  s_cmp_lg_u32 s73, 0
  s_cbranch_scc1 L_poll_q
L_polld_q:
  v_mov_b32 v173, v174
  v_lshlrev_b32 v237, 3, v0
  ds_write_b64 v237, v[172:173] offset:0
  s_mov_b32 exec_hi, -1
  v_mov_b32 v238, s80
  v_mov_b32 v239, s81
  ds_write_b64 v1, v[238:239] offset:256
  s_getreg_b32 s82, hwreg(HW_REG_XCC_ID, 0, 4)
  s_add_u32 s82, s82, 1
  s_lshl_b32 s82, s82, 24
  s_xor_b32 s82, s82, s81
L_waitfl:
  s_sleep 4
  ds_read_b32 v236, v1 offset:288
  s_waitcnt lgkmcnt(0)
  v_cmp_eq_u32 vcc, 0, v236
  s_cbranch_vccnz L_waitfl
  s_min_u32 s66, s60, 12
  s_mul_i32 s85, s60, 5
  s_add_u32 s85, s85, s66
  s_cmp_lt_u32 s60, 12
  s_cselect_b32 s65, 6, 5
  s_lshl_b32 s68, s85, 5
  s_add_u32 s68, s68, 262144
  s_lshl_b32 s69, s65, 1
  v_mov_b32 v172, 0
  v_mov_b32 v173, 0
  v_mov_b32 v174, 0
  v_mov_b32 v175, 0
  s_bfm_b64 exec, s69, 0
  buffer_load_dwordx4 v[172:175], v3, s[56:59], s68 offen sc1
  s_mov_b64 exec, -1
  s_min_u32 s66, s60, 12
  s_mul_i32 s85, s60, 5
  s_add_u32 s85, s85, s66
  s_cmp_lt_u32 s60, 12
  s_cselect_b32 s65, 6, 5
  s_mov_b32 s52, s18
  s_mov_b32 s53, s19
  s_mov_b32 s54, 1409024
  s_mov_b32 s55, 0x00020000
  v_lshrrev_b32 v241, 3, v0
  v_and_b32 v242, 7, v0
  v_lshlrev_b32 v242, 4, v242
  v_lshl_add_u32 v243, v241, 10, v242
  s_lshl_b32 s66, s85, 13
  s_lshl_b32 s67, s61, 7
  s_add_u32 s66, s66, s67
  buffer_load_dwordx4 v[148:151], v243, s[52:55], s66 offen nt
  s_add_u32 s66, s66, 8192
  buffer_load_dwordx4 v[152:155], v243, s[52:55], s66 offen nt
  s_add_u32 s66, s66, 8192
  buffer_load_dwordx4 v[156:159], v243, s[52:55], s66 offen nt
  s_add_u32 s66, s66, 8192
  buffer_load_dwordx4 v[160:163], v243, s[52:55], s66 offen nt
  s_add_u32 s66, s66, 8192
  buffer_load_dwordx4 v[164:167], v243, s[52:55], s66 offen nt
  s_add_u32 s66, s66, 8192
  s_cmp_eq_u32 s65, 6
  s_cselect_b32 s54, s54, 0
  s_cselect_b32 s66, s66, 0
  buffer_load_dwordx4 v[168:171], v243, s[52:55], s66 offen nt
  s_mov_b32 s40, s12
  s_mov_b32 s41, s13
  s_mov_b32 s42, 4194304
  s_mov_b32 s43, 0x00020000
  s_lshl_b32 s66, s60, 17
  s_lshl_b32 s67, s61, 7
  s_add_u32 s66, s66, s67
  s_add_u32 s67, s66, 0
  buffer_load_dwordx4 v[84:87], v228, s[40:43], s67 offen nt
  buffer_load_dwordx4 v[116:119], v228, s[40:43], s67 offen offset:1024 nt
  s_add_u32 s67, s66, 8192
  buffer_load_dwordx4 v[88:91], v228, s[40:43], s67 offen nt
  buffer_load_dwordx4 v[120:123], v228, s[40:43], s67 offen offset:1024 nt
  s_add_u32 s67, s66, 16384
  buffer_load_dwordx4 v[92:95], v228, s[40:43], s67 offen nt
  buffer_load_dwordx4 v[124:127], v228, s[40:43], s67 offen offset:1024 nt
  s_add_u32 s67, s66, 24576
  buffer_load_dwordx4 v[96:99], v228, s[40:43], s67 offen nt
  buffer_load_dwordx4 v[128:131], v228, s[40:43], s67 offen offset:1024 nt
  s_add_u32 s67, s66, 4096
  buffer_load_dwordx4 v[100:103], v228, s[40:43], s67 offen nt
  buffer_load_dwordx4 v[132:135], v228, s[40:43], s67 offen offset:1024 nt
  s_add_u32 s67, s66, 12288
  buffer_load_dwordx4 v[104:107], v228, s[40:43], s67 offen nt
  buffer_load_dwordx4 v[136:139], v228, s[40:43], s67 offen offset:1024 nt
  s_add_u32 s67, s66, 20480
  buffer_load_dwordx4 v[108:111], v228, s[40:43], s67 offen nt
  buffer_load_dwordx4 v[140:143], v228, s[40:43], s67 offen offset:1024 nt
  s_add_u32 s67, s66, 28672
  buffer_load_dwordx4 v[112:115], v228, s[40:43], s67 offen nt
  buffer_load_dwordx4 v[144:147], v228, s[40:43], s67 offen offset:1024 nt
  s_bfm_b64 exec, s69, 0
  s_waitcnt vmcnt(22)
  v_xor_b32 v244, s80, v173
  v_xor_b32 v245, s81, v175
  v_or_b32 v246, v244, v245
  v_cmp_ne_u32 vcc, 0, v246
  s_cbranch_vccz L_polld_h
  s_mov_b32 s73, 400000
L_poll_h:
  buffer_load_dwordx4 v[172:175], v3, s[56:59], s68 offen sc1
  s_sub_u32 s73, s73, 1
  s_waitcnt vmcnt(0)
  v_xor_b32 v244, s80, v173
  v_xor_b32 v245, s81, v175
  v_or_b32 v246, v244, v245
  v_cmp_ne_u32 vcc, 0, v246
  s_cbranch_vccz L_polld_h
  s_cmp_lg_u32 s73, 0
  s_cbranch_scc1 L_poll_h
L_polld_h:
  s_mov_b64 exec, 0xffff
  v_mov_b32 v173, v174
  v_lshlrev_b32 v240, 3, v0
  ds_write_b64 v240, v[172:173] offset:320
  s_mov_b64 exec, -1
  v_lshrrev_b32 v241, 3, v0
  v_lshlrev_b32 v241, 1, v241
  ds_read_u16 v176, v241 offset:320
  ds_read_u16 v177, v241 offset:336
  ds_read_u16 v178, v241 offset:352
  ds_read_u16 v179, v241 offset:368
  ds_read_u16 v180, v241 offset:384
  ds_read_u16 v181, v241 offset:400
  s_waitcnt lgkmcnt(0)
  v_lshl_or_b32 v176, v176, 16, v176
  v_lshl_or_b32 v177, v177, 16, v177
  v_lshl_or_b32 v178, v178, 16, v178
  v_lshl_or_b32 v179, v179, 16, v179
  v_lshl_or_b32 v180, v180, 16, v180
  v_lshl_or_b32 v181, v181, 16, v181
  s_waitcnt vmcnt(16)
  v_and_b32 v24, v176, v20
  v_and_b32 v25, v176, v21
  v_and_b32 v26, v176, v22
  v_and_b32 v27, v176, v23
  v_and_b32 v28, v177, v20
  v_and_b32 v29, v177, v21
  v_and_b32 v30, v177, v22
  v_and_b32 v31, v177, v23
  v_mfma_f32_16x16x32_bf16 v[16:19], v[24:27], v[148:151], 0
  v_and_b32 v24, v178, v20
  v_and_b32 v25, v178, v21
  v_and_b32 v26, v178, v22
  v_and_b32 v27, v178, v23
  v_mfma_f32_16x16x32_bf16 v[16:19], v[28:31], v[152:155], v[16:19]
  v_and_b32 v28, v179, v20
  v_and_b32 v29, v179, v21
  v_and_b32 v30, v179, v22
  v_and_b32 v31, v179, v23
  v_mfma_f32_16x16x32_bf16 v[16:19], v[24:27], v[156:159], v[16:19]
  v_and_b32 v24, v180, v20
  v_and_b32 v25, v180, v21
  v_and_b32 v26, v180, v22
  v_and_b32 v27, v180, v23
  v_mfma_f32_16x16x32_bf16 v[16:19], v[28:31], v[160:163], v[16:19]
  v_and_b32 v28, v181, v20
  v_and_b32 v29, v181, v21
  v_and_b32 v30, v181, v22
  v_and_b32 v31, v181, v23
  v_mfma_f32_16x16x32_bf16 v[16:19], v[24:27], v[164:167], v[16:19]
  s_nop 0
  v_mfma_f32_16x16x32_bf16 v[16:19], v[28:31], v[168:171], v[16:19]
  s_lshl_b32 s66, s61, 14
  s_lshl_b32 s67, s60, 9
  s_add_u32 s66, s66, s67
  s_add_u32 s66, s66, 851968
  v_and_b32 v236, 0x1ff, v11
  v_mov_b32 v233, s80
  v_mov_b32 v235, s81
  s_nop 1
  v_permlane32_swap_b32 v16, v18
  v_permlane32_swap_b32 v17, v19
  s_nop 1
  v_add_f32_dpp v232, v18, v16 row_ror:8 row_mask:0xf bank_mask:0xf
  v_add_f32_dpp v234, v19, v17 row_ror:8 row_mask:0xf bank_mask:0xf
  s_mov_b32 exec_lo, 0x00ff00ff
  s_mov_b32 exec_hi, 0x00ff00ff
  buffer_store_dwordx4 v[232:235], v236, s[56:59], s66 offen sc1
  s_mov_b64 exec, -1
  s_mov_b32 s62, s66
  s_branch L_tail0b
L_stream:
  s_mov_b64 exec, 1
  ds_add_rtn_u32 v226, v1, v227 offset:264
  s_mov_b64 exec, -1
  s_mov_b32 s64, 4
L_K0:
  s_waitcnt vmcnt(8)
  v_mfma_f32_16x16x32_bf16 v[16:19], a[0:3], v[36:39], 0
  v_mfma_f32_16x16x32_bf16 v[16:19], a[4:7], v[40:43], v[16:19]
  v_mfma_f32_16x16x32_bf16 v[16:19], a[8:11], v[44:47], v[16:19]
  v_mfma_f32_16x16x32_bf16 v[16:19], a[12:15], v[48:51], v[16:19]
  s_waitcnt lgkmcnt(0)
  v_readfirstlane_b32 s91, v226
  v_add_u32 v231, s36, v230
  s_cmp_ge_u32 s91, s26
  s_cbranch_scc1 L_T1m0
  s_mov_b64 exec, 1
  ds_add_rtn_u32 v226, v1, v227 offset:264
  s_mov_b64 exec, -1
  s_lshr_b32 s93, s91, 3
  s_lshl_b32 s93, s93, 3
  s_add_u32 s93, s93, s90
  s_lshl_b32 s93, s93, 1
  s_lshl_b32 s94, s63, 1
  s_add_u32 s94, s91, s94
  s_and_b32 s94, s94, 7
  s_lshl_b32 s93, s93, 14
  s_lshl_b32 s94, s94, 12
  s_add_u32 s93, s93, s94
  s_add_u32 s92, s93, s74
  s_lshl_b32 s93, s91, 12
  s_add_u32 s93, s93, s65
  s_cmp_ge_u32 s91, 240
  s_cselect_b32 s92, s93, s92
  s_lshl_b32 s36, s91, 8
  v_mul_f32_dpp v24, v16, v6 quad_perm:[0,0,0,0] row_mask:0xf bank_mask:0xf
  v_mul_f32_dpp v25, v17, v6 quad_perm:[1,1,1,1] row_mask:0xf bank_mask:0xf
  v_mul_f32_dpp v26, v18, v6 quad_perm:[2,2,2,2] row_mask:0xf bank_mask:0xf
  v_mul_f32_dpp v27, v19, v6 quad_perm:[3,3,3,3] row_mask:0xf bank_mask:0xf
  v_add_f32 v24, v24, v25
  v_add_f32 v26, v26, v27
  v_add_f32 v7, v24, v26
  v_max_f32 v4, v4, v7
  ds_write_b32 v231, v7 offset:4096
  s_waitcnt vmcnt(5)
  buffer_load_dwordx4 a[0:3], v2, s[28:31], s92 offen offset:0 nt
  s_waitcnt vmcnt(6)
  buffer_load_dwordx4 a[4:7], v2, s[28:31], s92 offen offset:1024 nt
  s_waitcnt vmcnt(6)
  buffer_load_dwordx4 a[8:11], v2, s[28:31], s92 offen offset:2048 nt
  s_waitcnt vmcnt(6)
  buffer_load_dwordx4 a[12:15], v2, s[28:31], s92 offen offset:3072 nt
  s_waitcnt vmcnt(8)
  v_mfma_f32_16x16x32_bf16 v[16:19], a[16:19], v[36:39], 0
  v_mfma_f32_16x16x32_bf16 v[16:19], a[20:23], v[40:43], v[16:19]
  v_mfma_f32_16x16x32_bf16 v[16:19], a[24:27], v[44:47], v[16:19]
  v_mfma_f32_16x16x32_bf16 v[16:19], a[28:31], v[48:51], v[16:19]
  s_waitcnt lgkmcnt(0)
  v_readfirstlane_b32 s91, v226
  v_add_u32 v231, s37, v230
  s_cmp_ge_u32 s91, s26
  s_cbranch_scc1 L_T1m1
  s_mov_b64 exec, 1
  ds_add_rtn_u32 v226, v1, v227 offset:264
  s_mov_b64 exec, -1
  s_lshr_b32 s93, s91, 3
  s_lshl_b32 s93, s93, 3
  s_add_u32 s93, s93, s90
  s_lshl_b32 s93, s93, 1
  s_lshl_b32 s94, s63, 1
  s_add_u32 s94, s91, s94
  s_and_b32 s94, s94, 7
  s_lshl_b32 s93, s93, 14
  s_lshl_b32 s94, s94, 12
  s_add_u32 s93, s93, s94
  s_add_u32 s92, s93, s74
  s_lshl_b32 s93, s91, 12
  s_add_u32 s93, s93, s65
  s_cmp_ge_u32 s91, 240
  s_cselect_b32 s92, s93, s92
  s_lshl_b32 s37, s91, 8
  v_mul_f32_dpp v24, v16, v6 quad_perm:[0,0,0,0] row_mask:0xf bank_mask:0xf
  v_mul_f32_dpp v25, v17, v6 quad_perm:[1,1,1,1] row_mask:0xf bank_mask:0xf
  v_mul_f32_dpp v26, v18, v6 quad_perm:[2,2,2,2] row_mask:0xf bank_mask:0xf
  v_mul_f32_dpp v27, v19, v6 quad_perm:[3,3,3,3] row_mask:0xf bank_mask:0xf
  v_add_f32 v24, v24, v25
  v_add_f32 v26, v26, v27
  v_add_f32 v7, v24, v26
  v_max_f32 v4, v4, v7
  ds_write_b32 v231, v7 offset:4096
  s_waitcnt vmcnt(5)
  buffer_load_dwordx4 a[16:19], v2, s[28:31], s92 offen offset:0 nt
  s_waitcnt vmcnt(6)
  buffer_load_dwordx4 a[20:23], v2, s[28:31], s92 offen offset:1024 nt
  s_waitcnt vmcnt(6)
  buffer_load_dwordx4 a[24:27], v2, s[28:31], s92 offen offset:2048 nt
  s_waitcnt vmcnt(6)
  buffer_load_dwordx4 a[28:31], v2, s[28:31], s92 offen offset:3072 nt
  s_waitcnt vmcnt(8)
  v_mfma_f32_16x16x32_bf16 v[16:19], a[32:35], v[36:39], 0
  v_mfma_f32_16x16x32_bf16 v[16:19], a[36:39], v[40:43], v[16:19]
  v_mfma_f32_16x16x32_bf16 v[16:19], a[40:43], v[44:47], v[16:19]
  v_mfma_f32_16x16x32_bf16 v[16:19], a[44:47], v[48:51], v[16:19]
  s_waitcnt lgkmcnt(0)
  v_readfirstlane_b32 s91, v226
  v_add_u32 v231, s38, v230
  s_cmp_ge_u32 s91, s26
  s_cbranch_scc1 L_T1m2
  s_mov_b64 exec, 1
  ds_add_rtn_u32 v226, v1, v227 offset:264
  s_mov_b64 exec, -1
  s_lshr_b32 s93, s91, 3
  s_lshl_b32 s93, s93, 3
  s_add_u32 s93, s93, s90
  s_lshl_b32 s93, s93, 1
  s_lshl_b32 s94, s63, 1
  s_add_u32 s94, s91, s94
  s_and_b32 s94, s94, 7
  s_lshl_b32 s93, s93, 14
  s_lshl_b32 s94, s94, 12
  s_add_u32 s93, s93, s94
  s_add_u32 s92, s93, s74
  s_lshl_b32 s93, s91, 12
  s_add_u32 s93, s93, s65
  s_cmp_ge_u32 s91, 240
  s_cselect_b32 s92, s93, s92
  s_lshl_b32 s38, s91, 8
  v_mul_f32_dpp v24, v16, v6 quad_perm:[0,0,0,0] row_mask:0xf bank_mask:0xf
  v_mul_f32_dpp v25, v17, v6 quad_perm:[1,1,1,1] row_mask:0xf bank_mask:0xf
  v_mul_f32_dpp v26, v18, v6 quad_perm:[2,2,2,2] row_mask:0xf bank_mask:0xf
  v_mul_f32_dpp v27, v19, v6 quad_perm:[3,3,3,3] row_mask:0xf bank_mask:0xf
  v_add_f32 v24, v24, v25
  v_add_f32 v26, v26, v27
  v_add_f32 v7, v24, v26
  v_max_f32 v4, v4, v7
  ds_write_b32 v231, v7 offset:4096
  s_waitcnt vmcnt(5)
  buffer_load_dwordx4 a[32:35], v2, s[28:31], s92 offen offset:0 nt
  s_waitcnt vmcnt(6)
  buffer_load_dwordx4 a[36:39], v2, s[28:31], s92 offen offset:1024 nt
  s_waitcnt vmcnt(6)
  buffer_load_dwordx4 a[40:43], v2, s[28:31], s92 offen offset:2048 nt
  s_waitcnt vmcnt(6)
  buffer_load_dwordx4 a[44:47], v2, s[28:31], s92 offen offset:3072 nt
  s_waitcnt vmcnt(8)
  v_mfma_f32_16x16x32_bf16 v[16:19], a[48:51], v[36:39], 0
  v_mfma_f32_16x16x32_bf16 v[16:19], a[52:55], v[40:43], v[16:19]
  v_mfma_f32_16x16x32_bf16 v[16:19], a[56:59], v[44:47], v[16:19]
  v_mfma_f32_16x16x32_bf16 v[16:19], a[60:63], v[48:51], v[16:19]
  s_waitcnt lgkmcnt(0)
  v_readfirstlane_b32 s91, v226
  v_add_u32 v231, s39, v230
  s_cmp_ge_u32 s91, s26
  s_cbranch_scc1 L_T1m3
  s_mov_b64 exec, 1
  ds_add_rtn_u32 v226, v1, v227 offset:264
  s_mov_b64 exec, -1
  s_lshr_b32 s93, s91, 3
  s_lshl_b32 s93, s93, 3
  s_add_u32 s93, s93, s90
  s_lshl_b32 s93, s93, 1
  s_lshl_b32 s94, s63, 1
  s_add_u32 s94, s91, s94
  s_and_b32 s94, s94, 7
  s_lshl_b32 s93, s93, 14
  s_lshl_b32 s94, s94, 12
  s_add_u32 s93, s93, s94
  s_add_u32 s92, s93, s74
  s_lshl_b32 s93, s91, 12
  s_add_u32 s93, s93, s65
  s_cmp_ge_u32 s91, 240
  s_cselect_b32 s92, s93, s92
  s_lshl_b32 s39, s91, 8
  v_mul_f32_dpp v24, v16, v6 quad_perm:[0,0,0,0] row_mask:0xf bank_mask:0xf
  v_mul_f32_dpp v25, v17, v6 quad_perm:[1,1,1,1] row_mask:0xf bank_mask:0xf
  v_mul_f32_dpp v26, v18, v6 quad_perm:[2,2,2,2] row_mask:0xf bank_mask:0xf
  v_mul_f32_dpp v27, v19, v6 quad_perm:[3,3,3,3] row_mask:0xf bank_mask:0xf
  v_add_f32 v24, v24, v25
  v_add_f32 v26, v26, v27
  v_add_f32 v7, v24, v26
  v_max_f32 v4, v4, v7
  ds_write_b32 v231, v7 offset:4096
  s_waitcnt vmcnt(5)
  buffer_load_dwordx4 a[48:51], v2, s[28:31], s92 offen offset:0 nt
  s_waitcnt vmcnt(6)
  buffer_load_dwordx4 a[52:55], v2, s[28:31], s92 offen offset:1024 nt
  s_waitcnt vmcnt(6)
  buffer_load_dwordx4 a[56:59], v2, s[28:31], s92 offen offset:2048 nt
  s_waitcnt vmcnt(6)
  buffer_load_dwordx4 a[60:63], v2, s[28:31], s92 offen offset:3072 nt
  s_branch L_K0
L_T1s0:
  s_sub_u32 s64, s64, 1
  s_cmp_eq_u32 s64, 0
  s_cbranch_scc1 L_sync0
  s_waitcnt vmcnt(8)
  v_mfma_f32_16x16x32_bf16 v[16:19], a[0:3], v[36:39], 0
  v_mfma_f32_16x16x32_bf16 v[16:19], a[4:7], v[40:43], v[16:19]
  v_mfma_f32_16x16x32_bf16 v[16:19], a[8:11], v[44:47], v[16:19]
  v_mfma_f32_16x16x32_bf16 v[16:19], a[12:15], v[48:51], v[16:19]
  s_waitcnt lgkmcnt(0)
  v_readfirstlane_b32 s91, v226
  v_add_u32 v231, s36, v230
L_T1m0:
  s_mov_b64 exec, 1
  ds_add_rtn_u32 v226, v1, v227 offset:264
  s_mov_b64 exec, -1
  s_sub_u32 s91, s91, s26
  s_cmp_lt_u32 s91, s26
  s_cselect_b32 s34, 0x10000000, 0
  s_min_u32 s91, s91, s26
  s_lshr_b32 s93, s91, 3
  s_lshl_b32 s93, s93, 3
  s_add_u32 s93, s93, s90
  s_lshl_b32 s93, s93, 1
  s_lshl_b32 s94, s63, 1
  s_add_u32 s94, s91, s94
  s_and_b32 s94, s94, 7
  s_lshl_b32 s93, s93, 14
  s_lshl_b32 s94, s94, 12
  s_add_u32 s93, s93, s94
  s_add_u32 s92, s93, s74
  s_lshl_b32 s93, s91, 12
  s_add_u32 s93, s93, s65
  s_cmp_ge_u32 s91, 240
  s_cselect_b32 s92, s93, s92
  s_lshl_b32 s36, s91, 8
  v_mul_f32_dpp v24, v16, v6 quad_perm:[0,0,0,0] row_mask:0xf bank_mask:0xf
  v_mul_f32_dpp v25, v17, v6 quad_perm:[1,1,1,1] row_mask:0xf bank_mask:0xf
  v_mul_f32_dpp v26, v18, v6 quad_perm:[2,2,2,2] row_mask:0xf bank_mask:0xf
  v_mul_f32_dpp v27, v19, v6 quad_perm:[3,3,3,3] row_mask:0xf bank_mask:0xf
  v_add_f32 v24, v24, v25
  v_add_f32 v26, v26, v27
  v_add_f32 v7, v24, v26
  v_max_f32 v4, v4, v7
  ds_write_b32 v231, v7 offset:4096
  s_cmp_lg_u32 s64, 1
  s_cbranch_scc1 L_T1n0
  s_nop 0
  v_max_f32_dpp v8, v4, v4 row_ror:4 row_mask:0xf bank_mask:0xf
  s_nop 1
  v_max_f32_dpp v8, v8, v8 row_ror:8 row_mask:0xf bank_mask:0xf
  s_nop 0
  v_readlane_b32 s96, v8, 0
  v_readlane_b32 s97, v8, 16
  v_readlane_b32 s98, v8, 32
  v_readlane_b32 s99, v8, 48
  s_nop 1
  v_mov_b32 v8, s96
  v_max_f32 v8, s97, v8
  v_max_f32 v8, s98, v8
  v_max_f32 v8, s99, v8
  s_lshl_b32 s66, s3, 2
  v_mov_b32 v7, s66
  s_mov_b64 exec, 1
  ds_write_b32 v7, v8 offset:272
  ds_add_u32 v1, v227 offset:268
  s_mov_b64 exec, -1
L_T1n0:
  s_waitcnt vmcnt(6)
  buffer_load_dwordx4 a[0:3], v3, s[32:35], s92 offen offset:0 nt
  s_waitcnt vmcnt(6)
  buffer_load_dwordx4 a[4:7], v3, s[32:35], s92 offen offset:1024 nt
  s_waitcnt vmcnt(6)
  buffer_load_dwordx4 a[8:11], v3, s[32:35], s92 offen offset:2048 nt
  s_waitcnt vmcnt(6)
  buffer_load_dwordx4 a[12:15], v3, s[32:35], s92 offen offset:3072 nt
L_T1s1:
  s_sub_u32 s64, s64, 1
  s_cmp_eq_u32 s64, 0
  s_cbranch_scc1 L_sync1
  s_waitcnt vmcnt(8)
  v_mfma_f32_16x16x32_bf16 v[16:19], a[16:19], v[36:39], 0
  v_mfma_f32_16x16x32_bf16 v[16:19], a[20:23], v[40:43], v[16:19]
  v_mfma_f32_16x16x32_bf16 v[16:19], a[24:27], v[44:47], v[16:19]
  v_mfma_f32_16x16x32_bf16 v[16:19], a[28:31], v[48:51], v[16:19]
  s_waitcnt lgkmcnt(0)
  v_readfirstlane_b32 s91, v226
  v_add_u32 v231, s37, v230
L_T1m1:
  s_mov_b64 exec, 1
  ds_add_rtn_u32 v226, v1, v227 offset:264
  s_mov_b64 exec, -1
  s_sub_u32 s91, s91, s26
  s_cmp_lt_u32 s91, s26
  s_cselect_b32 s34, 0x10000000, 0
  s_min_u32 s91, s91, s26
  s_lshr_b32 s93, s91, 3
  s_lshl_b32 s93, s93, 3
  s_add_u32 s93, s93, s90
  s_lshl_b32 s93, s93, 1
  s_lshl_b32 s94, s63, 1
  s_add_u32 s94, s91, s94
  s_and_b32 s94, s94, 7
  s_lshl_b32 s93, s93, 14
  s_lshl_b32 s94, s94, 12
  s_add_u32 s93, s93, s94
  s_add_u32 s92, s93, s74
  s_lshl_b32 s93, s91, 12
  s_add_u32 s93, s93, s65
  s_cmp_ge_u32 s91, 240
  s_cselect_b32 s92, s93, s92
  s_lshl_b32 s37, s91, 8
  v_mul_f32_dpp v24, v16, v6 quad_perm:[0,0,0,0] row_mask:0xf bank_mask:0xf
  v_mul_f32_dpp v25, v17, v6 quad_perm:[1,1,1,1] row_mask:0xf bank_mask:0xf
  v_mul_f32_dpp v26, v18, v6 quad_perm:[2,2,2,2] row_mask:0xf bank_mask:0xf
  v_mul_f32_dpp v27, v19, v6 quad_perm:[3,3,3,3] row_mask:0xf bank_mask:0xf
  v_add_f32 v24, v24, v25
  v_add_f32 v26, v26, v27
  v_add_f32 v7, v24, v26
  v_max_f32 v4, v4, v7
  ds_write_b32 v231, v7 offset:4096
  s_cmp_lg_u32 s64, 1
  s_cbranch_scc1 L_T1n1
  s_nop 0
  v_max_f32_dpp v8, v4, v4 row_ror:4 row_mask:0xf bank_mask:0xf
  s_nop 1
  v_max_f32_dpp v8, v8, v8 row_ror:8 row_mask:0xf bank_mask:0xf
  s_nop 0
  v_readlane_b32 s96, v8, 0
  v_readlane_b32 s97, v8, 16
  v_readlane_b32 s98, v8, 32
  v_readlane_b32 s99, v8, 48
  s_nop 1
  v_mov_b32 v8, s96
  v_max_f32 v8, s97, v8
  v_max_f32 v8, s98, v8
  v_max_f32 v8, s99, v8
  s_lshl_b32 s66, s3, 2
  v_mov_b32 v7, s66
  s_mov_b64 exec, 1
  ds_write_b32 v7, v8 offset:272
  ds_add_u32 v1, v227 offset:268
  s_mov_b64 exec, -1
L_T1n1:
  s_waitcnt vmcnt(6)
  buffer_load_dwordx4 a[16:19], v3, s[32:35], s92 offen offset:0 nt
  s_waitcnt vmcnt(6)
  buffer_load_dwordx4 a[20:23], v3, s[32:35], s92 offen offset:1024 nt
  s_waitcnt vmcnt(6)
  buffer_load_dwordx4 a[24:27], v3, s[32:35], s92 offen offset:2048 nt
  s_waitcnt vmcnt(6)
  buffer_load_dwordx4 a[28:31], v3, s[32:35], s92 offen offset:3072 nt
L_T1s2:
  s_sub_u32 s64, s64, 1
  s_cmp_eq_u32 s64, 0
  s_cbranch_scc1 L_sync2
  s_waitcnt vmcnt(8)
  v_mfma_f32_16x16x32_bf16 v[16:19], a[32:35], v[36:39], 0
  v_mfma_f32_16x16x32_bf16 v[16:19], a[36:39], v[40:43], v[16:19]
  v_mfma_f32_16x16x32_bf16 v[16:19], a[40:43], v[44:47], v[16:19]
  v_mfma_f32_16x16x32_bf16 v[16:19], a[44:47], v[48:51], v[16:19]
  s_waitcnt lgkmcnt(0)
  v_readfirstlane_b32 s91, v226
  v_add_u32 v231, s38, v230
L_T1m2:
  s_mov_b64 exec, 1
  ds_add_rtn_u32 v226, v1, v227 offset:264
  s_mov_b64 exec, -1
  s_sub_u32 s91, s91, s26
  s_cmp_lt_u32 s91, s26
  s_cselect_b32 s34, 0x10000000, 0
  s_min_u32 s91, s91, s26
  s_lshr_b32 s93, s91, 3
  s_lshl_b32 s93, s93, 3
  s_add_u32 s93, s93, s90
  s_lshl_b32 s93, s93, 1
  s_lshl_b32 s94, s63, 1
  s_add_u32 s94, s91, s94
  s_and_b32 s94, s94, 7
  s_lshl_b32 s93, s93, 14
  s_lshl_b32 s94, s94, 12
  s_add_u32 s93, s93, s94
  s_add_u32 s92, s93, s74
  s_lshl_b32 s93, s91, 12
  s_add_u32 s93, s93, s65
  s_cmp_ge_u32 s91, 240
  s_cselect_b32 s92, s93, s92
  s_lshl_b32 s38, s91, 8
  v_mul_f32_dpp v24, v16, v6 quad_perm:[0,0,0,0] row_mask:0xf bank_mask:0xf
  v_mul_f32_dpp v25, v17, v6 quad_perm:[1,1,1,1] row_mask:0xf bank_mask:0xf
  v_mul_f32_dpp v26, v18, v6 quad_perm:[2,2,2,2] row_mask:0xf bank_mask:0xf
  v_mul_f32_dpp v27, v19, v6 quad_perm:[3,3,3,3] row_mask:0xf bank_mask:0xf
  v_add_f32 v24, v24, v25
  v_add_f32 v26, v26, v27
  v_add_f32 v7, v24, v26
  v_max_f32 v4, v4, v7
  ds_write_b32 v231, v7 offset:4096
  s_cmp_lg_u32 s64, 1
  s_cbranch_scc1 L_T1n2
  s_nop 0
  v_max_f32_dpp v8, v4, v4 row_ror:4 row_mask:0xf bank_mask:0xf
  s_nop 1
  v_max_f32_dpp v8, v8, v8 row_ror:8 row_mask:0xf bank_mask:0xf
  s_nop 0
  v_readlane_b32 s96, v8, 0
  v_readlane_b32 s97, v8, 16
  v_readlane_b32 s98, v8, 32
  v_readlane_b32 s99, v8, 48
  s_nop 1
  v_mov_b32 v8, s96
  v_max_f32 v8, s97, v8
  v_max_f32 v8, s98, v8
  v_max_f32 v8, s99, v8
  s_lshl_b32 s66, s3, 2
  v_mov_b32 v7, s66
  s_mov_b64 exec, 1
  ds_write_b32 v7, v8 offset:272
  ds_add_u32 v1, v227 offset:268
  s_mov_b64 exec, -1
L_T1n2:
  s_waitcnt vmcnt(6)
  buffer_load_dwordx4 a[32:35], v3, s[32:35], s92 offen offset:0 nt
  s_waitcnt vmcnt(6)
  buffer_load_dwordx4 a[36:39], v3, s[32:35], s92 offen offset:1024 nt
  s_waitcnt vmcnt(6)
  buffer_load_dwordx4 a[40:43], v3, s[32:35], s92 offen offset:2048 nt
  s_waitcnt vmcnt(6)
  buffer_load_dwordx4 a[44:47], v3, s[32:35], s92 offen offset:3072 nt
L_T1s3:
  s_sub_u32 s64, s64, 1
  s_cmp_eq_u32 s64, 0
  s_cbranch_scc1 L_sync3
  s_waitcnt vmcnt(8)
  v_mfma_f32_16x16x32_bf16 v[16:19], a[48:51], v[36:39], 0
  v_mfma_f32_16x16x32_bf16 v[16:19], a[52:55], v[40:43], v[16:19]
  v_mfma_f32_16x16x32_bf16 v[16:19], a[56:59], v[44:47], v[16:19]
  v_mfma_f32_16x16x32_bf16 v[16:19], a[60:63], v[48:51], v[16:19]
  s_waitcnt lgkmcnt(0)
  v_readfirstlane_b32 s91, v226
  v_add_u32 v231, s39, v230
L_T1m3:
  s_mov_b64 exec, 1
  ds_add_rtn_u32 v226, v1, v227 offset:264
  s_mov_b64 exec, -1
  s_sub_u32 s91, s91, s26
  s_cmp_lt_u32 s91, s26
  s_cselect_b32 s34, 0x10000000, 0
  s_min_u32 s91, s91, s26
  s_lshr_b32 s93, s91, 3
  s_lshl_b32 s93, s93, 3
  s_add_u32 s93, s93, s90
  s_lshl_b32 s93, s93, 1
  s_lshl_b32 s94, s63, 1
  s_add_u32 s94, s91, s94
  s_and_b32 s94, s94, 7
  s_lshl_b32 s93, s93, 14
  s_lshl_b32 s94, s94, 12
  s_add_u32 s93, s93, s94
  s_add_u32 s92, s93, s74
  s_lshl_b32 s93, s91, 12
  s_add_u32 s93, s93, s65
  s_cmp_ge_u32 s91, 240
  s_cselect_b32 s92, s93, s92
  s_lshl_b32 s39, s91, 8
  v_mul_f32_dpp v24, v16, v6 quad_perm:[0,0,0,0] row_mask:0xf bank_mask:0xf
  v_mul_f32_dpp v25, v17, v6 quad_perm:[1,1,1,1] row_mask:0xf bank_mask:0xf
  v_mul_f32_dpp v26, v18, v6 quad_perm:[2,2,2,2] row_mask:0xf bank_mask:0xf
  v_mul_f32_dpp v27, v19, v6 quad_perm:[3,3,3,3] row_mask:0xf bank_mask:0xf
  v_add_f32 v24, v24, v25
  v_add_f32 v26, v26, v27
  v_add_f32 v7, v24, v26
  v_max_f32 v4, v4, v7
  ds_write_b32 v231, v7 offset:4096
  s_cmp_lg_u32 s64, 1
  s_cbranch_scc1 L_T1n3
  s_nop 0
  v_max_f32_dpp v8, v4, v4 row_ror:4 row_mask:0xf bank_mask:0xf
  s_nop 1
  v_max_f32_dpp v8, v8, v8 row_ror:8 row_mask:0xf bank_mask:0xf
  s_nop 0
  v_readlane_b32 s96, v8, 0
  v_readlane_b32 s97, v8, 16
  v_readlane_b32 s98, v8, 32
  v_readlane_b32 s99, v8, 48
  s_nop 1
  v_mov_b32 v8, s96
  v_max_f32 v8, s97, v8
  v_max_f32 v8, s98, v8
  v_max_f32 v8, s99, v8
  s_lshl_b32 s66, s3, 2
  v_mov_b32 v7, s66
  s_mov_b64 exec, 1
  ds_write_b32 v7, v8 offset:272
  ds_add_u32 v1, v227 offset:268
  s_mov_b64 exec, -1
L_T1n3:
  s_waitcnt vmcnt(6)
  buffer_load_dwordx4 a[48:51], v3, s[32:35], s92 offen offset:0 nt
  s_waitcnt vmcnt(6)
  buffer_load_dwordx4 a[52:55], v3, s[32:35], s92 offen offset:1024 nt
  s_waitcnt vmcnt(6)
  buffer_load_dwordx4 a[56:59], v3, s[32:35], s92 offen offset:2048 nt
  s_waitcnt vmcnt(6)
  buffer_load_dwordx4 a[60:63], v3, s[32:35], s92 offen offset:3072 nt
  s_branch L_T1s0
L_sync0:
  ds_read_b32 v7, v1 offset:268
  ds_read_b128 v[24:27], v1 offset:272
  s_waitcnt lgkmcnt(0)
  v_cmp_gt_u32 vcc, 3, v7
  s_cbranch_vccnz L_sync0
  v_max3_f32 v4, v25, v26, v27
  s_mov_b32 s34, 0x10000000
  s_branch L_V0
L_sync1:
  ds_read_b32 v7, v1 offset:268
  ds_read_b128 v[24:27], v1 offset:272
  s_waitcnt lgkmcnt(0)
  v_cmp_gt_u32 vcc, 3, v7
  s_cbranch_vccnz L_sync1
  v_max3_f32 v4, v25, v26, v27
  s_mov_b32 s34, 0x10000000
  s_branch L_V1
L_sync2:
  ds_read_b32 v7, v1 offset:268
  ds_read_b128 v[24:27], v1 offset:272
  s_waitcnt lgkmcnt(0)
  v_cmp_gt_u32 vcc, 3, v7
  s_cbranch_vccnz L_sync2
  v_max3_f32 v4, v25, v26, v27
  s_mov_b32 s34, 0x10000000
  s_branch L_V2
L_sync3:
  ds_read_b32 v7, v1 offset:268
  ds_read_b128 v[24:27], v1 offset:272
  s_waitcnt lgkmcnt(0)
  v_cmp_gt_u32 vcc, 3, v7
  s_cbranch_vccnz L_sync3
  v_max3_f32 v4, v25, v26, v27
  s_mov_b32 s34, 0x10000000
  s_branch L_V3
L_V0:
  v_add_u32 v231, s36, v230
  ds_read_b32 v7, v231 offset:4096
  s_waitcnt vmcnt(12) lgkmcnt(0)
  v_readfirstlane_b32 s91, v226
  v_sub_f32 v8, v7, v4
  v_exp_f32 v8, v8
  s_nop 0
  v_cvt_pk_bf16_f32 v8, v8, v8
  v_and_b32 v12, v8, v9
  v_and_b32 v13, v8, v10
  s_nop 0
  s_sub_u32 s91, s91, s26
  v_mfma_f32_16x16x16_bf16 v[220:223], v[224:225], v[12:13], v[220:223]
  v_mfma_f32_16x16x16_bf16 v[52:55], a[0:1], v[12:13], v[52:55]
  v_mfma_f32_16x16x16_bf16 v[56:59], a[2:3], v[12:13], v[56:59]
  v_mfma_f32_16x16x16_bf16 v[60:63], a[4:5], v[12:13], v[60:63]
  v_mfma_f32_16x16x16_bf16 v[64:67], a[6:7], v[12:13], v[64:67]
  v_mfma_f32_16x16x16_bf16 v[68:71], a[8:9], v[12:13], v[68:71]
  v_mfma_f32_16x16x16_bf16 v[72:75], a[10:11], v[12:13], v[72:75]
  v_mfma_f32_16x16x16_bf16 v[76:79], a[12:13], v[12:13], v[76:79]
  v_mfma_f32_16x16x16_bf16 v[80:83], a[14:15], v[12:13], v[80:83]
L_Vm0:
  s_cmp_ge_u32 s91, s27
  s_cbranch_scc1 L_VE0
  s_mov_b64 exec, 1
  ds_add_rtn_u32 v226, v1, v227 offset:264
  s_mov_b64 exec, -1
  s_lshr_b32 s93, s91, 3
  s_lshl_b32 s93, s93, 3
  s_add_u32 s93, s93, s90
  s_lshl_b32 s93, s93, 1
  s_lshl_b32 s94, s63, 1
  s_add_u32 s94, s91, s94
  s_and_b32 s94, s94, 7
  s_lshl_b32 s93, s93, 14
  s_lshl_b32 s94, s94, 12
  s_add_u32 s93, s93, s94
  s_add_u32 s92, s93, s74
  s_lshl_b32 s93, s91, 12
  s_add_u32 s93, s93, s65
  s_cmp_ge_u32 s91, 240
  s_cselect_b32 s92, s93, s92
  s_lshl_b32 s36, s91, 8
  s_waitcnt vmcnt(6)
  buffer_load_dwordx4 a[0:3], v3, s[32:35], s92 offen offset:0 nt
  s_waitcnt vmcnt(6)
  buffer_load_dwordx4 a[4:7], v3, s[32:35], s92 offen offset:1024 nt
  s_waitcnt vmcnt(6)
  buffer_load_dwordx4 a[8:11], v3, s[32:35], s92 offen offset:2048 nt
  s_waitcnt vmcnt(6)
  buffer_load_dwordx4 a[12:15], v3, s[32:35], s92 offen offset:3072 nt
L_V1:
  v_add_u32 v231, s37, v230
  ds_read_b32 v7, v231 offset:4096
  s_waitcnt vmcnt(12) lgkmcnt(0)
  v_readfirstlane_b32 s91, v226
  v_sub_f32 v8, v7, v4
  v_exp_f32 v8, v8
  s_nop 0
  v_cvt_pk_bf16_f32 v8, v8, v8
  v_and_b32 v12, v8, v9
  v_and_b32 v13, v8, v10
  s_nop 0
  s_sub_u32 s91, s91, s26
  v_mfma_f32_16x16x16_bf16 v[220:223], v[224:225], v[12:13], v[220:223]
  v_mfma_f32_16x16x16_bf16 v[52:55], a[16:17], v[12:13], v[52:55]
  v_mfma_f32_16x16x16_bf16 v[56:59], a[18:19], v[12:13], v[56:59]
  v_mfma_f32_16x16x16_bf16 v[60:63], a[20:21], v[12:13], v[60:63]
  v_mfma_f32_16x16x16_bf16 v[64:67], a[22:23], v[12:13], v[64:67]
  v_mfma_f32_16x16x16_bf16 v[68:71], a[24:25], v[12:13], v[68:71]
  v_mfma_f32_16x16x16_bf16 v[72:75], a[26:27], v[12:13], v[72:75]
  v_mfma_f32_16x16x16_bf16 v[76:79], a[28:29], v[12:13], v[76:79]
  v_mfma_f32_16x16x16_bf16 v[80:83], a[30:31], v[12:13], v[80:83]
L_Vm1:
  s_cmp_ge_u32 s91, s27
  s_cbranch_scc1 L_VE1
  s_mov_b64 exec, 1
  ds_add_rtn_u32 v226, v1, v227 offset:264
  s_mov_b64 exec, -1
  s_lshr_b32 s93, s91, 3
  s_lshl_b32 s93, s93, 3
  s_add_u32 s93, s93, s90
  s_lshl_b32 s93, s93, 1
  s_lshl_b32 s94, s63, 1
  s_add_u32 s94, s91, s94
  s_and_b32 s94, s94, 7
  s_lshl_b32 s93, s93, 14
  s_lshl_b32 s94, s94, 12
  s_add_u32 s93, s93, s94
  s_add_u32 s92, s93, s74
  s_lshl_b32 s93, s91, 12
  s_add_u32 s93, s93, s65
  s_cmp_ge_u32 s91, 240
  s_cselect_b32 s92, s93, s92
  s_lshl_b32 s37, s91, 8
  s_waitcnt vmcnt(6)
  buffer_load_dwordx4 a[16:19], v3, s[32:35], s92 offen offset:0 nt
  s_waitcnt vmcnt(6)
  buffer_load_dwordx4 a[20:23], v3, s[32:35], s92 offen offset:1024 nt
  s_waitcnt vmcnt(6)
  buffer_load_dwordx4 a[24:27], v3, s[32:35], s92 offen offset:2048 nt
  s_waitcnt vmcnt(6)
  buffer_load_dwordx4 a[28:31], v3, s[32:35], s92 offen offset:3072 nt
L_V2:
  v_add_u32 v231, s38, v230
  ds_read_b32 v7, v231 offset:4096
  s_waitcnt vmcnt(12) lgkmcnt(0)
  v_readfirstlane_b32 s91, v226
  v_sub_f32 v8, v7, v4
  v_exp_f32 v8, v8
  s_nop 0
  v_cvt_pk_bf16_f32 v8, v8, v8
  v_and_b32 v12, v8, v9
  v_and_b32 v13, v8, v10
  s_nop 0
  s_sub_u32 s91, s91, s26
  v_mfma_f32_16x16x16_bf16 v[220:223], v[224:225], v[12:13], v[220:223]
  v_mfma_f32_16x16x16_bf16 v[52:55], a[32:33], v[12:13], v[52:55]
  v_mfma_f32_16x16x16_bf16 v[56:59], a[34:35], v[12:13], v[56:59]
  v_mfma_f32_16x16x16_bf16 v[60:63], a[36:37], v[12:13], v[60:63]
  v_mfma_f32_16x16x16_bf16 v[64:67], a[38:39], v[12:13], v[64:67]
  v_mfma_f32_16x16x16_bf16 v[68:71], a[40:41], v[12:13], v[68:71]
  v_mfma_f32_16x16x16_bf16 v[72:75], a[42:43], v[12:13], v[72:75]
  v_mfma_f32_16x16x16_bf16 v[76:79], a[44:45], v[12:13], v[76:79]
  v_mfma_f32_16x16x16_bf16 v[80:83], a[46:47], v[12:13], v[80:83]
L_Vm2:
  s_cmp_ge_u32 s91, s27
  s_cbranch_scc1 L_VE2
  s_mov_b64 exec, 1
  ds_add_rtn_u32 v226, v1, v227 offset:264
  s_mov_b64 exec, -1
  s_lshr_b32 s93, s91, 3
  s_lshl_b32 s93, s93, 3
  s_add_u32 s93, s93, s90
  s_lshl_b32 s93, s93, 1
  s_lshl_b32 s94, s63, 1
  s_add_u32 s94, s91, s94
  s_and_b32 s94, s94, 7
  s_lshl_b32 s93, s93, 14
  s_lshl_b32 s94, s94, 12
  s_add_u32 s93, s93, s94
  s_add_u32 s92, s93, s74
  s_lshl_b32 s93, s91, 12
  s_add_u32 s93, s93, s65
  s_cmp_ge_u32 s91, 240
  s_cselect_b32 s92, s93, s92
  s_lshl_b32 s38, s91, 8
  s_waitcnt vmcnt(6)
  buffer_load_dwordx4 a[32:35], v3, s[32:35], s92 offen offset:0 nt
  s_waitcnt vmcnt(6)
  buffer_load_dwordx4 a[36:39], v3, s[32:35], s92 offen offset:1024 nt
  s_waitcnt vmcnt(6)
  buffer_load_dwordx4 a[40:43], v3, s[32:35], s92 offen offset:2048 nt
  s_waitcnt vmcnt(6)
  buffer_load_dwordx4 a[44:47], v3, s[32:35], s92 offen offset:3072 nt
L_V3:
  v_add_u32 v231, s39, v230
  ds_read_b32 v7, v231 offset:4096
  s_waitcnt vmcnt(12) lgkmcnt(0)
  v_readfirstlane_b32 s91, v226
  v_sub_f32 v8, v7, v4
  v_exp_f32 v8, v8
  s_nop 0
  v_cvt_pk_bf16_f32 v8, v8, v8
  v_and_b32 v12, v8, v9
  v_and_b32 v13, v8, v10
  s_nop 0
  s_sub_u32 s91, s91, s26
  v_mfma_f32_16x16x16_bf16 v[220:223], v[224:225], v[12:13], v[220:223]
  v_mfma_f32_16x16x16_bf16 v[52:55], a[48:49], v[12:13], v[52:55]
  v_mfma_f32_16x16x16_bf16 v[56:59], a[50:51], v[12:13], v[56:59]
  v_mfma_f32_16x16x16_bf16 v[60:63], a[52:53], v[12:13], v[60:63]
  v_mfma_f32_16x16x16_bf16 v[64:67], a[54:55], v[12:13], v[64:67]
  v_mfma_f32_16x16x16_bf16 v[68:71], a[56:57], v[12:13], v[68:71]
  v_mfma_f32_16x16x16_bf16 v[72:75], a[58:59], v[12:13], v[72:75]
  v_mfma_f32_16x16x16_bf16 v[76:79], a[60:61], v[12:13], v[76:79]
  v_mfma_f32_16x16x16_bf16 v[80:83], a[62:63], v[12:13], v[80:83]
L_Vm3:
  s_cmp_ge_u32 s91, s27
  s_cbranch_scc1 L_VE3
  s_mov_b64 exec, 1
  ds_add_rtn_u32 v226, v1, v227 offset:264
  s_mov_b64 exec, -1
  s_lshr_b32 s93, s91, 3
  s_lshl_b32 s93, s93, 3
  s_add_u32 s93, s93, s90
  s_lshl_b32 s93, s93, 1
  s_lshl_b32 s94, s63, 1
  s_add_u32 s94, s91, s94
  s_and_b32 s94, s94, 7
  s_lshl_b32 s93, s93, 14
  s_lshl_b32 s94, s94, 12
  s_add_u32 s93, s93, s94
  s_add_u32 s92, s93, s74
  s_lshl_b32 s93, s91, 12
  s_add_u32 s93, s93, s65
  s_cmp_ge_u32 s91, 240
  s_cselect_b32 s92, s93, s92
  s_lshl_b32 s39, s91, 8
  s_waitcnt vmcnt(6)
  buffer_load_dwordx4 a[48:51], v3, s[32:35], s92 offen offset:0 nt
  s_waitcnt vmcnt(6)
  buffer_load_dwordx4 a[52:55], v3, s[32:35], s92 offen offset:1024 nt
  s_waitcnt vmcnt(6)
  buffer_load_dwordx4 a[56:59], v3, s[32:35], s92 offen offset:2048 nt
  s_waitcnt vmcnt(6)
  buffer_load_dwordx4 a[60:63], v3, s[32:35], s92 offen offset:3072 nt
  s_branch L_V0
L_VE0:
  s_mov_b32 s84, 1
  s_atomic_add s84, s[86:87], 0x0 glc
  s_branch L_Wm0
L_VE1:
  s_mov_b32 s84, 1
  s_atomic_add s84, s[86:87], 0x0 glc
  s_branch L_Wm1
L_VE2:
  s_mov_b32 s84, 1
  s_atomic_add s84, s[86:87], 0x0 glc
  s_branch L_Wm2
L_VE3:
  s_mov_b32 s84, 1
  s_atomic_add s84, s[86:87], 0x0 glc
  s_branch L_Wm3
L_W0:
  v_add_u32 v231, s36, v230
  ds_read_b32 v7, v231 offset:4096
  s_waitcnt vmcnt(12) lgkmcnt(0)
  v_readfirstlane_b32 s91, v226
  v_sub_f32 v8, v7, v4
  v_exp_f32 v8, v8
  s_nop 0
  v_cvt_pk_bf16_f32 v8, v8, v8
  v_and_b32 v12, v8, v9
  v_and_b32 v13, v8, v10
  s_nop 0
  s_sub_u32 s91, s91, s26
  v_mfma_f32_16x16x16_bf16 v[220:223], v[224:225], v[12:13], v[220:223]
  v_mfma_f32_16x16x16_bf16 v[52:55], a[0:1], v[12:13], v[52:55]
  v_mfma_f32_16x16x16_bf16 v[56:59], a[2:3], v[12:13], v[56:59]
  v_mfma_f32_16x16x16_bf16 v[60:63], a[4:5], v[12:13], v[60:63]
  v_mfma_f32_16x16x16_bf16 v[64:67], a[6:7], v[12:13], v[64:67]
  v_mfma_f32_16x16x16_bf16 v[68:71], a[8:9], v[12:13], v[68:71]
  v_mfma_f32_16x16x16_bf16 v[72:75], a[10:11], v[12:13], v[72:75]
  v_mfma_f32_16x16x16_bf16 v[76:79], a[12:13], v[12:13], v[76:79]
  v_mfma_f32_16x16x16_bf16 v[80:83], a[14:15], v[12:13], v[80:83]
L_Wm0:
  s_cmp_ge_u32 s91, s26
  s_cbranch_scc1 L_T2_0
  s_mov_b64 exec, 1
  ds_add_rtn_u32 v226, v1, v227 offset:264
  s_mov_b64 exec, -1
  s_lshr_b32 s93, s91, 3
  s_lshl_b32 s93, s93, 3
  s_add_u32 s93, s93, s90
  s_lshl_b32 s93, s93, 1
  s_lshl_b32 s94, s63, 1
  s_add_u32 s94, s91, s94
  s_and_b32 s94, s94, 7
  s_lshl_b32 s93, s93, 14
  s_lshl_b32 s94, s94, 12
  s_add_u32 s93, s93, s94
  s_add_u32 s92, s93, s74
  s_lshl_b32 s93, s91, 12
  s_add_u32 s93, s93, s65
  s_cmp_ge_u32 s91, 240
  s_cselect_b32 s92, s93, s92
  s_lshl_b32 s36, s91, 8
  s_waitcnt vmcnt(12)
  buffer_load_dwordx4 a[0:3], v3, s[32:35], s92 offen offset:0 nt
  s_waitcnt vmcnt(12)
  buffer_load_dwordx4 a[4:7], v3, s[32:35], s92 offen offset:1024 nt
  s_waitcnt vmcnt(12)
  buffer_load_dwordx4 a[8:11], v3, s[32:35], s92 offen offset:2048 nt
  s_waitcnt vmcnt(12)
  buffer_load_dwordx4 a[12:15], v3, s[32:35], s92 offen offset:3072 nt
L_W1:
  v_add_u32 v231, s37, v230
  ds_read_b32 v7, v231 offset:4096
  s_waitcnt vmcnt(12) lgkmcnt(0)
  v_readfirstlane_b32 s91, v226
  v_sub_f32 v8, v7, v4
  v_exp_f32 v8, v8
  s_nop 0
  v_cvt_pk_bf16_f32 v8, v8, v8
  v_and_b32 v12, v8, v9
  v_and_b32 v13, v8, v10
  s_nop 0
  s_sub_u32 s91, s91, s26
  v_mfma_f32_16x16x16_bf16 v[220:223], v[224:225], v[12:13], v[220:223]
  v_mfma_f32_16x16x16_bf16 v[52:55], a[16:17], v[12:13], v[52:55]
  v_mfma_f32_16x16x16_bf16 v[56:59], a[18:19], v[12:13], v[56:59]
  v_mfma_f32_16x16x16_bf16 v[60:63], a[20:21], v[12:13], v[60:63]
  v_mfma_f32_16x16x16_bf16 v[64:67], a[22:23], v[12:13], v[64:67]
  v_mfma_f32_16x16x16_bf16 v[68:71], a[24:25], v[12:13], v[68:71]
  v_mfma_f32_16x16x16_bf16 v[72:75], a[26:27], v[12:13], v[72:75]
  v_mfma_f32_16x16x16_bf16 v[76:79], a[28:29], v[12:13], v[76:79]
  v_mfma_f32_16x16x16_bf16 v[80:83], a[30:31], v[12:13], v[80:83]
L_Wm1:
  s_cmp_ge_u32 s91, s26
  s_cbranch_scc1 L_T2_1
  s_mov_b64 exec, 1
  ds_add_rtn_u32 v226, v1, v227 offset:264
  s_mov_b64 exec, -1
  s_lshr_b32 s93, s91, 3
  s_lshl_b32 s93, s93, 3
  s_add_u32 s93, s93, s90
  s_lshl_b32 s93, s93, 1
  s_lshl_b32 s94, s63, 1
  s_add_u32 s94, s91, s94
  s_and_b32 s94, s94, 7
  s_lshl_b32 s93, s93, 14
  s_lshl_b32 s94, s94, 12
  s_add_u32 s93, s93, s94
  s_add_u32 s92, s93, s74
  s_lshl_b32 s93, s91, 12
  s_add_u32 s93, s93, s65
  s_cmp_ge_u32 s91, 240
  s_cselect_b32 s92, s93, s92
  s_lshl_b32 s37, s91, 8
  s_waitcnt vmcnt(12)
  buffer_load_dwordx4 a[16:19], v3, s[32:35], s92 offen offset:0 nt
  s_waitcnt vmcnt(12)
  buffer_load_dwordx4 a[20:23], v3, s[32:35], s92 offen offset:1024 nt
  s_waitcnt vmcnt(12)
  buffer_load_dwordx4 a[24:27], v3, s[32:35], s92 offen offset:2048 nt
  s_waitcnt vmcnt(12)
  buffer_load_dwordx4 a[28:31], v3, s[32:35], s92 offen offset:3072 nt
L_W2:
  v_add_u32 v231, s38, v230
  ds_read_b32 v7, v231 offset:4096
  s_waitcnt vmcnt(12) lgkmcnt(0)
  v_readfirstlane_b32 s91, v226
  v_sub_f32 v8, v7, v4
  v_exp_f32 v8, v8
  s_nop 0
  v_cvt_pk_bf16_f32 v8, v8, v8
  v_and_b32 v12, v8, v9
  v_and_b32 v13, v8, v10
  s_nop 0
  s_sub_u32 s91, s91, s26
  v_mfma_f32_16x16x16_bf16 v[220:223], v[224:225], v[12:13], v[220:223]
  v_mfma_f32_16x16x16_bf16 v[52:55], a[32:33], v[12:13], v[52:55]
  v_mfma_f32_16x16x16_bf16 v[56:59], a[34:35], v[12:13], v[56:59]
  v_mfma_f32_16x16x16_bf16 v[60:63], a[36:37], v[12:13], v[60:63]
  v_mfma_f32_16x16x16_bf16 v[64:67], a[38:39], v[12:13], v[64:67]
  v_mfma_f32_16x16x16_bf16 v[68:71], a[40:41], v[12:13], v[68:71]
  v_mfma_f32_16x16x16_bf16 v[72:75], a[42:43], v[12:13], v[72:75]
  v_mfma_f32_16x16x16_bf16 v[76:79], a[44:45], v[12:13], v[76:79]
  v_mfma_f32_16x16x16_bf16 v[80:83], a[46:47], v[12:13], v[80:83]
L_Wm2:
  s_cmp_ge_u32 s91, s26
  s_cbranch_scc1 L_T2_2
  s_mov_b64 exec, 1
  ds_add_rtn_u32 v226, v1, v227 offset:264
  s_mov_b64 exec, -1
  s_lshr_b32 s93, s91, 3
  s_lshl_b32 s93, s93, 3
  s_add_u32 s93, s93, s90
  s_lshl_b32 s93, s93, 1
  s_lshl_b32 s94, s63, 1
  s_add_u32 s94, s91, s94
  s_and_b32 s94, s94, 7
  s_lshl_b32 s93, s93, 14
  s_lshl_b32 s94, s94, 12
  s_add_u32 s93, s93, s94
  s_add_u32 s92, s93, s74
  s_lshl_b32 s93, s91, 12
  s_add_u32 s93, s93, s65
  s_cmp_ge_u32 s91, 240
  s_cselect_b32 s92, s93, s92
  s_lshl_b32 s38, s91, 8
  s_waitcnt vmcnt(12)
  buffer_load_dwordx4 a[32:35], v3, s[32:35], s92 offen offset:0 nt
  s_waitcnt vmcnt(12)
  buffer_load_dwordx4 a[36:39], v3, s[32:35], s92 offen offset:1024 nt
  s_waitcnt vmcnt(12)
  buffer_load_dwordx4 a[40:43], v3, s[32:35], s92 offen offset:2048 nt
  s_waitcnt vmcnt(12)
  buffer_load_dwordx4 a[44:47], v3, s[32:35], s92 offen offset:3072 nt
L_W3:
  v_add_u32 v231, s39, v230
  ds_read_b32 v7, v231 offset:4096
  s_waitcnt vmcnt(12) lgkmcnt(0)
  v_readfirstlane_b32 s91, v226
  v_sub_f32 v8, v7, v4
  v_exp_f32 v8, v8
  s_nop 0
  v_cvt_pk_bf16_f32 v8, v8, v8
  v_and_b32 v12, v8, v9
  v_and_b32 v13, v8, v10
  s_nop 0
  s_sub_u32 s91, s91, s26
  v_mfma_f32_16x16x16_bf16 v[220:223], v[224:225], v[12:13], v[220:223]
  v_mfma_f32_16x16x16_bf16 v[52:55], a[48:49], v[12:13], v[52:55]
  v_mfma_f32_16x16x16_bf16 v[56:59], a[50:51], v[12:13], v[56:59]
  v_mfma_f32_16x16x16_bf16 v[60:63], a[52:53], v[12:13], v[60:63]
  v_mfma_f32_16x16x16_bf16 v[64:67], a[54:55], v[12:13], v[64:67]
  v_mfma_f32_16x16x16_bf16 v[68:71], a[56:57], v[12:13], v[68:71]
  v_mfma_f32_16x16x16_bf16 v[72:75], a[58:59], v[12:13], v[72:75]
  v_mfma_f32_16x16x16_bf16 v[76:79], a[60:61], v[12:13], v[76:79]
  v_mfma_f32_16x16x16_bf16 v[80:83], a[62:63], v[12:13], v[80:83]
L_Wm3:
  s_cmp_ge_u32 s91, s26
  s_cbranch_scc1 L_T2_3
  s_mov_b64 exec, 1
  ds_add_rtn_u32 v226, v1, v227 offset:264
  s_mov_b64 exec, -1
  s_lshr_b32 s93, s91, 3
  s_lshl_b32 s93, s93, 3
  s_add_u32 s93, s93, s90
  s_lshl_b32 s93, s93, 1
  s_lshl_b32 s94, s63, 1
  s_add_u32 s94, s91, s94
  s_and_b32 s94, s94, 7
  s_lshl_b32 s93, s93, 14
  s_lshl_b32 s94, s94, 12
  s_add_u32 s93, s93, s94
  s_add_u32 s92, s93, s74
  s_lshl_b32 s93, s91, 12
  s_add_u32 s93, s93, s65
  s_cmp_ge_u32 s91, 240
  s_cselect_b32 s92, s93, s92
  s_lshl_b32 s39, s91, 8
  s_waitcnt vmcnt(12)
  buffer_load_dwordx4 a[48:51], v3, s[32:35], s92 offen offset:0 nt
  s_waitcnt vmcnt(12)
  buffer_load_dwordx4 a[52:55], v3, s[32:35], s92 offen offset:1024 nt
  s_waitcnt vmcnt(12)
  buffer_load_dwordx4 a[56:59], v3, s[32:35], s92 offen offset:2048 nt
  s_waitcnt vmcnt(12)
  buffer_load_dwordx4 a[60:63], v3, s[32:35], s92 offen offset:3072 nt
  s_branch L_W0
L_T2_0:
  v_add_u32 v231, s37, v230
  ds_read_b32 v236, v231 offset:4096
  v_add_u32 v231, s38, v230
  ds_read_b32 v237, v231 offset:4096
  v_add_u32 v231, s39, v230
  ds_read_b32 v238, v231 offset:4096
  s_waitcnt lgkmcnt(0)
  s_waitcnt lgkmcnt(0)
  s_cmp_lt_u32 s84, s53
  s_cselect_b32 s30, 0x10000000, 0
  s_cselect_b32 s34, 0x10000000, 0
  s_cselect_b32 s89, s88, 1
  s_cselect_b32 s62, s84, 0
  s_cbranch_scc0 L_inv1
  s_mov_b32 s84, 1
  s_atomic_add s84, s[86:87], 0x0 glc
L_notk1:
  s_min_u32 s88, s88, s89
  s_add_u32 s62, s62, s52
  s_lshr_b32 s93, s62, 2
  s_and_b32 s94, s62, 3
  s_lshl_b32 s93, s93, 14
  s_lshl_b32 s94, s94, 12
  s_add_u32 s93, s93, s94
  s_add_u32 s92, s93, s74
L_tkd1:
  s_waitcnt vmcnt(12)
  buffer_load_dwordx4 a[0:3], v2, s[28:31], s92 offen offset:0 nt
  s_waitcnt vmcnt(12)
  buffer_load_dwordx4 a[4:7], v2, s[28:31], s92 offen offset:1024 nt
  s_waitcnt vmcnt(12)
  buffer_load_dwordx4 a[8:11], v2, s[28:31], s92 offen offset:2048 nt
  s_waitcnt vmcnt(12)
  buffer_load_dwordx4 a[12:15], v2, s[28:31], s92 offen offset:3072 nt
  v_sub_f32 v8, v236, v4
  v_exp_f32 v8, v8
  s_nop 0
  v_cvt_pk_bf16_f32 v8, v8, v8
  v_and_b32 v12, v8, v9
  v_and_b32 v13, v8, v10
  s_waitcnt vmcnt(8)
  s_nop 0
  v_mfma_f32_16x16x16_bf16 v[220:223], v[224:225], v[12:13], v[220:223]
  v_mfma_f32_16x16x16_bf16 v[52:55], a[16:17], v[12:13], v[52:55]
  v_mfma_f32_16x16x16_bf16 v[56:59], a[18:19], v[12:13], v[56:59]
  v_mfma_f32_16x16x16_bf16 v[60:63], a[20:21], v[12:13], v[60:63]
  v_mfma_f32_16x16x16_bf16 v[64:67], a[22:23], v[12:13], v[64:67]
  v_mfma_f32_16x16x16_bf16 v[68:71], a[24:25], v[12:13], v[68:71]
  v_mfma_f32_16x16x16_bf16 v[72:75], a[26:27], v[12:13], v[72:75]
  v_mfma_f32_16x16x16_bf16 v[76:79], a[28:29], v[12:13], v[76:79]
  v_mfma_f32_16x16x16_bf16 v[80:83], a[30:31], v[12:13], v[80:83]
  s_waitcnt vmcnt(12)
  buffer_load_dwordx4 a[16:19], v3, s[32:35], s92 offen offset:0 nt
  s_waitcnt vmcnt(12)
  buffer_load_dwordx4 a[20:23], v3, s[32:35], s92 offen offset:1024 nt
  s_waitcnt vmcnt(12)
  buffer_load_dwordx4 a[24:27], v3, s[32:35], s92 offen offset:2048 nt
  s_waitcnt vmcnt(12)
  buffer_load_dwordx4 a[28:31], v3, s[32:35], s92 offen offset:3072 nt
  v_sub_f32 v8, v237, v4
  v_exp_f32 v8, v8
  s_nop 0
  v_cvt_pk_bf16_f32 v8, v8, v8
  v_and_b32 v12, v8, v9
  v_and_b32 v13, v8, v10
  s_waitcnt vmcnt(8)
  s_nop 0
  v_mfma_f32_16x16x16_bf16 v[220:223], v[224:225], v[12:13], v[220:223]
  v_mfma_f32_16x16x16_bf16 v[52:55], a[32:33], v[12:13], v[52:55]
  v_mfma_f32_16x16x16_bf16 v[56:59], a[34:35], v[12:13], v[56:59]
  v_mfma_f32_16x16x16_bf16 v[60:63], a[36:37], v[12:13], v[60:63]
  v_mfma_f32_16x16x16_bf16 v[64:67], a[38:39], v[12:13], v[64:67]
  v_mfma_f32_16x16x16_bf16 v[68:71], a[40:41], v[12:13], v[68:71]
  v_mfma_f32_16x16x16_bf16 v[72:75], a[42:43], v[12:13], v[72:75]
  v_mfma_f32_16x16x16_bf16 v[76:79], a[44:45], v[12:13], v[76:79]
  v_mfma_f32_16x16x16_bf16 v[80:83], a[46:47], v[12:13], v[80:83]
  s_waitcnt lgkmcnt(0)
  s_cmp_lt_u32 s84, s53
  s_cselect_b32 s30, 0x10000000, 0
  s_cselect_b32 s34, 0x10000000, 0
  s_cselect_b32 s89, s88, 2
  s_cselect_b32 s62, s84, 0
  s_cbranch_scc0 L_inv2
  s_mov_b32 s84, 1
  s_atomic_add s84, s[86:87], 0x0 glc
L_notk2:
  s_min_u32 s88, s88, s89
  s_add_u32 s62, s62, s52
  s_lshr_b32 s93, s62, 2
  s_and_b32 s94, s62, 3
  s_lshl_b32 s93, s93, 14
  s_lshl_b32 s94, s94, 12
  s_add_u32 s93, s93, s94
  s_add_u32 s92, s93, s74
L_tkd2:
  s_waitcnt vmcnt(12)
  buffer_load_dwordx4 a[32:35], v2, s[28:31], s92 offen offset:0 nt
  s_waitcnt vmcnt(12)
  buffer_load_dwordx4 a[36:39], v2, s[28:31], s92 offen offset:1024 nt
  s_waitcnt vmcnt(12)
  buffer_load_dwordx4 a[40:43], v2, s[28:31], s92 offen offset:2048 nt
  s_waitcnt vmcnt(12)
  buffer_load_dwordx4 a[44:47], v2, s[28:31], s92 offen offset:3072 nt
  v_sub_f32 v8, v238, v4
  v_exp_f32 v8, v8
  s_nop 0
  v_cvt_pk_bf16_f32 v8, v8, v8
  v_and_b32 v12, v8, v9
  v_and_b32 v13, v8, v10
  s_waitcnt vmcnt(8)
  s_nop 0
  v_mfma_f32_16x16x16_bf16 v[220:223], v[224:225], v[12:13], v[220:223]
  v_mfma_f32_16x16x16_bf16 v[52:55], a[48:49], v[12:13], v[52:55]
  v_mfma_f32_16x16x16_bf16 v[56:59], a[50:51], v[12:13], v[56:59]
  v_mfma_f32_16x16x16_bf16 v[60:63], a[52:53], v[12:13], v[60:63]
  v_mfma_f32_16x16x16_bf16 v[64:67], a[54:55], v[12:13], v[64:67]
  v_mfma_f32_16x16x16_bf16 v[68:71], a[56:57], v[12:13], v[68:71]
  v_mfma_f32_16x16x16_bf16 v[72:75], a[58:59], v[12:13], v[72:75]
  v_mfma_f32_16x16x16_bf16 v[76:79], a[60:61], v[12:13], v[76:79]
  v_mfma_f32_16x16x16_bf16 v[80:83], a[62:63], v[12:13], v[80:83]
  s_waitcnt vmcnt(12)
  buffer_load_dwordx4 a[48:51], v3, s[32:35], s92 offen offset:0 nt
  s_waitcnt vmcnt(12)
  buffer_load_dwordx4 a[52:55], v3, s[32:35], s92 offen offset:1024 nt
  s_waitcnt vmcnt(12)
  buffer_load_dwordx4 a[56:59], v3, s[32:35], s92 offen offset:2048 nt
  s_waitcnt vmcnt(12)
  buffer_load_dwordx4 a[60:63], v3, s[32:35], s92 offen offset:3072 nt
  s_branch L_dyn0
L_T2_1:
  v_add_u32 v231, s38, v230
  ds_read_b32 v236, v231 offset:4096
  v_add_u32 v231, s39, v230
  ds_read_b32 v237, v231 offset:4096
  v_add_u32 v231, s36, v230
  ds_read_b32 v238, v231 offset:4096
  s_waitcnt lgkmcnt(0)
  v_sub_f32 v8, v236, v4
  v_exp_f32 v8, v8
  s_nop 0
  v_cvt_pk_bf16_f32 v8, v8, v8
  v_and_b32 v12, v8, v9
  v_and_b32 v13, v8, v10
  s_waitcnt vmcnt(8)
  s_nop 0
  v_mfma_f32_16x16x16_bf16 v[220:223], v[224:225], v[12:13], v[220:223]
  v_mfma_f32_16x16x16_bf16 v[52:55], a[32:33], v[12:13], v[52:55]
  v_mfma_f32_16x16x16_bf16 v[56:59], a[34:35], v[12:13], v[56:59]
  v_mfma_f32_16x16x16_bf16 v[60:63], a[36:37], v[12:13], v[60:63]
  v_mfma_f32_16x16x16_bf16 v[64:67], a[38:39], v[12:13], v[64:67]
  v_mfma_f32_16x16x16_bf16 v[68:71], a[40:41], v[12:13], v[68:71]
  v_mfma_f32_16x16x16_bf16 v[72:75], a[42:43], v[12:13], v[72:75]
  v_mfma_f32_16x16x16_bf16 v[76:79], a[44:45], v[12:13], v[76:79]
  v_mfma_f32_16x16x16_bf16 v[80:83], a[46:47], v[12:13], v[80:83]
  s_waitcnt lgkmcnt(0)
  s_cmp_lt_u32 s84, s53
  s_cselect_b32 s30, 0x10000000, 0
  s_cselect_b32 s34, 0x10000000, 0
  s_cselect_b32 s89, s88, 1
  s_cselect_b32 s62, s84, 0
  s_cbranch_scc0 L_inv3
  s_mov_b32 s84, 1
  s_atomic_add s84, s[86:87], 0x0 glc
L_notk3:
  s_min_u32 s88, s88, s89
  s_add_u32 s62, s62, s52
  s_lshr_b32 s93, s62, 2
  s_and_b32 s94, s62, 3
  s_lshl_b32 s93, s93, 14
  s_lshl_b32 s94, s94, 12
  s_add_u32 s93, s93, s94
  s_add_u32 s92, s93, s74
L_tkd3:
  s_waitcnt vmcnt(12)
  buffer_load_dwordx4 a[32:35], v2, s[28:31], s92 offen offset:0 nt
  s_waitcnt vmcnt(12)
  buffer_load_dwordx4 a[36:39], v2, s[28:31], s92 offen offset:1024 nt
  s_waitcnt vmcnt(12)
  buffer_load_dwordx4 a[40:43], v2, s[28:31], s92 offen offset:2048 nt
  s_waitcnt vmcnt(12)
  buffer_load_dwordx4 a[44:47], v2, s[28:31], s92 offen offset:3072 nt
  v_sub_f32 v8, v237, v4
  v_exp_f32 v8, v8
  s_nop 0
  v_cvt_pk_bf16_f32 v8, v8, v8
  v_and_b32 v12, v8, v9
  v_and_b32 v13, v8, v10
  s_waitcnt vmcnt(8)
  s_nop 0
  v_mfma_f32_16x16x16_bf16 v[220:223], v[224:225], v[12:13], v[220:223]
  v_mfma_f32_16x16x16_bf16 v[52:55], a[48:49], v[12:13], v[52:55]
  v_mfma_f32_16x16x16_bf16 v[56:59], a[50:51], v[12:13], v[56:59]
  v_mfma_f32_16x16x16_bf16 v[60:63], a[52:53], v[12:13], v[60:63]
  v_mfma_f32_16x16x16_bf16 v[64:67], a[54:55], v[12:13], v[64:67]
  v_mfma_f32_16x16x16_bf16 v[68:71], a[56:57], v[12:13], v[68:71]
  v_mfma_f32_16x16x16_bf16 v[72:75], a[58:59], v[12:13], v[72:75]
  v_mfma_f32_16x16x16_bf16 v[76:79], a[60:61], v[12:13], v[76:79]
  v_mfma_f32_16x16x16_bf16 v[80:83], a[62:63], v[12:13], v[80:83]
  s_waitcnt vmcnt(12)
  buffer_load_dwordx4 a[48:51], v3, s[32:35], s92 offen offset:0 nt
  s_waitcnt vmcnt(12)
  buffer_load_dwordx4 a[52:55], v3, s[32:35], s92 offen offset:1024 nt
  s_waitcnt vmcnt(12)
  buffer_load_dwordx4 a[56:59], v3, s[32:35], s92 offen offset:2048 nt
  s_waitcnt vmcnt(12)
  buffer_load_dwordx4 a[60:63], v3, s[32:35], s92 offen offset:3072 nt
  v_sub_f32 v8, v238, v4
  v_exp_f32 v8, v8
  s_nop 0
  v_cvt_pk_bf16_f32 v8, v8, v8
  v_and_b32 v12, v8, v9
  v_and_b32 v13, v8, v10
  s_waitcnt vmcnt(8)
  s_nop 0
  v_mfma_f32_16x16x16_bf16 v[220:223], v[224:225], v[12:13], v[220:223]
  v_mfma_f32_16x16x16_bf16 v[52:55], a[0:1], v[12:13], v[52:55]
  v_mfma_f32_16x16x16_bf16 v[56:59], a[2:3], v[12:13], v[56:59]
  v_mfma_f32_16x16x16_bf16 v[60:63], a[4:5], v[12:13], v[60:63]
  v_mfma_f32_16x16x16_bf16 v[64:67], a[6:7], v[12:13], v[64:67]
  v_mfma_f32_16x16x16_bf16 v[68:71], a[8:9], v[12:13], v[68:71]
  v_mfma_f32_16x16x16_bf16 v[72:75], a[10:11], v[12:13], v[72:75]
  v_mfma_f32_16x16x16_bf16 v[76:79], a[12:13], v[12:13], v[76:79]
  v_mfma_f32_16x16x16_bf16 v[80:83], a[14:15], v[12:13], v[80:83]
  s_waitcnt lgkmcnt(0)
  s_cmp_lt_u32 s84, s53
  s_cselect_b32 s30, 0x10000000, 0
  s_cselect_b32 s34, 0x10000000, 0
  s_cselect_b32 s89, s88, 2
  s_cselect_b32 s62, s84, 0
  s_cbranch_scc0 L_inv4
  s_mov_b32 s84, 1
  s_atomic_add s84, s[86:87], 0x0 glc
L_notk4:
  s_min_u32 s88, s88, s89
  s_add_u32 s62, s62, s52
  s_lshr_b32 s93, s62, 2
  s_and_b32 s94, s62, 3
  s_lshl_b32 s93, s93, 14
  s_lshl_b32 s94, s94, 12
  s_add_u32 s93, s93, s94
  s_add_u32 s92, s93, s74
L_tkd4:
  s_waitcnt vmcnt(12)
  buffer_load_dwordx4 a[0:3], v2, s[28:31], s92 offen offset:0 nt
  s_waitcnt vmcnt(12)
  buffer_load_dwordx4 a[4:7], v2, s[28:31], s92 offen offset:1024 nt
  s_waitcnt vmcnt(12)
  buffer_load_dwordx4 a[8:11], v2, s[28:31], s92 offen offset:2048 nt
  s_waitcnt vmcnt(12)
  buffer_load_dwordx4 a[12:15], v2, s[28:31], s92 offen offset:3072 nt
  s_waitcnt vmcnt(12)
  buffer_load_dwordx4 a[16:19], v3, s[32:35], s92 offen offset:0 nt
  s_waitcnt vmcnt(12)
  buffer_load_dwordx4 a[20:23], v3, s[32:35], s92 offen offset:1024 nt
  s_waitcnt vmcnt(12)
  buffer_load_dwordx4 a[24:27], v3, s[32:35], s92 offen offset:2048 nt
  s_waitcnt vmcnt(12)
  buffer_load_dwordx4 a[28:31], v3, s[32:35], s92 offen offset:3072 nt
  s_branch L_dyn1
L_T2_2:
  v_add_u32 v231, s39, v230
  ds_read_b32 v236, v231 offset:4096
  v_add_u32 v231, s36, v230
  ds_read_b32 v237, v231 offset:4096
  v_add_u32 v231, s37, v230
  ds_read_b32 v238, v231 offset:4096
  s_waitcnt lgkmcnt(0)
  s_waitcnt lgkmcnt(0)
  s_cmp_lt_u32 s84, s53
  s_cselect_b32 s30, 0x10000000, 0
  s_cselect_b32 s34, 0x10000000, 0
  s_cselect_b32 s89, s88, 1
  s_cselect_b32 s62, s84, 0
  s_cbranch_scc0 L_inv5
  s_mov_b32 s84, 1
  s_atomic_add s84, s[86:87], 0x0 glc
L_notk5:
  s_min_u32 s88, s88, s89
  s_add_u32 s62, s62, s52
  s_lshr_b32 s93, s62, 2
  s_and_b32 s94, s62, 3
  s_lshl_b32 s93, s93, 14
  s_lshl_b32 s94, s94, 12
  s_add_u32 s93, s93, s94
  s_add_u32 s92, s93, s74
L_tkd5:
  s_waitcnt vmcnt(12)
  buffer_load_dwordx4 a[32:35], v2, s[28:31], s92 offen offset:0 nt
  s_waitcnt vmcnt(12)
  buffer_load_dwordx4 a[36:39], v2, s[28:31], s92 offen offset:1024 nt
  s_waitcnt vmcnt(12)
  buffer_load_dwordx4 a[40:43], v2, s[28:31], s92 offen offset:2048 nt
  s_waitcnt vmcnt(12)
  buffer_load_dwordx4 a[44:47], v2, s[28:31], s92 offen offset:3072 nt
  v_sub_f32 v8, v236, v4
  v_exp_f32 v8, v8
  s_nop 0
  v_cvt_pk_bf16_f32 v8, v8, v8
  v_and_b32 v12, v8, v9
  v_and_b32 v13, v8, v10
  s_waitcnt vmcnt(8)
  s_nop 0
  v_mfma_f32_16x16x16_bf16 v[220:223], v[224:225], v[12:13], v[220:223]
  v_mfma_f32_16x16x16_bf16 v[52:55], a[48:49], v[12:13], v[52:55]
  v_mfma_f32_16x16x16_bf16 v[56:59], a[50:51], v[12:13], v[56:59]
  v_mfma_f32_16x16x16_bf16 v[60:63], a[52:53], v[12:13], v[60:63]
  v_mfma_f32_16x16x16_bf16 v[64:67], a[54:55], v[12:13], v[64:67]
  v_mfma_f32_16x16x16_bf16 v[68:71], a[56:57], v[12:13], v[68:71]
  v_mfma_f32_16x16x16_bf16 v[72:75], a[58:59], v[12:13], v[72:75]
  v_mfma_f32_16x16x16_bf16 v[76:79], a[60:61], v[12:13], v[76:79]
  v_mfma_f32_16x16x16_bf16 v[80:83], a[62:63], v[12:13], v[80:83]
  s_waitcnt vmcnt(12)
  buffer_load_dwordx4 a[48:51], v3, s[32:35], s92 offen offset:0 nt
  s_waitcnt vmcnt(12)
  buffer_load_dwordx4 a[52:55], v3, s[32:35], s92 offen offset:1024 nt
  s_waitcnt vmcnt(12)
  buffer_load_dwordx4 a[56:59], v3, s[32:35], s92 offen offset:2048 nt
  s_waitcnt vmcnt(12)
  buffer_load_dwordx4 a[60:63], v3, s[32:35], s92 offen offset:3072 nt
  v_sub_f32 v8, v237, v4
  v_exp_f32 v8, v8
  s_nop 0
  v_cvt_pk_bf16_f32 v8, v8, v8
  v_and_b32 v12, v8, v9
  v_and_b32 v13, v8, v10
  s_waitcnt vmcnt(8)
  s_nop 0
  v_mfma_f32_16x16x16_bf16 v[220:223], v[224:225], v[12:13], v[220:223]
  v_mfma_f32_16x16x16_bf16 v[52:55], a[0:1], v[12:13], v[52:55]
  v_mfma_f32_16x16x16_bf16 v[56:59], a[2:3], v[12:13], v[56:59]
  v_mfma_f32_16x16x16_bf16 v[60:63], a[4:5], v[12:13], v[60:63]
  v_mfma_f32_16x16x16_bf16 v[64:67], a[6:7], v[12:13], v[64:67]
  v_mfma_f32_16x16x16_bf16 v[68:71], a[8:9], v[12:13], v[68:71]
  v_mfma_f32_16x16x16_bf16 v[72:75], a[10:11], v[12:13], v[72:75]
  v_mfma_f32_16x16x16_bf16 v[76:79], a[12:13], v[12:13], v[76:79]
  v_mfma_f32_16x16x16_bf16 v[80:83], a[14:15], v[12:13], v[80:83]
  s_waitcnt lgkmcnt(0)
  s_cmp_lt_u32 s84, s53
  s_cselect_b32 s30, 0x10000000, 0
  s_cselect_b32 s34, 0x10000000, 0
  s_cselect_b32 s89, s88, 2
  s_cselect_b32 s62, s84, 0
  s_cbranch_scc0 L_inv6
  s_mov_b32 s84, 1
  s_atomic_add s84, s[86:87], 0x0 glc
L_notk6:
  s_min_u32 s88, s88, s89
  s_add_u32 s62, s62, s52
  s_lshr_b32 s93, s62, 2
  s_and_b32 s94, s62, 3
  s_lshl_b32 s93, s93, 14
  s_lshl_b32 s94, s94, 12
  s_add_u32 s93, s93, s94
  s_add_u32 s92, s93, s74
L_tkd6:
  s_waitcnt vmcnt(12)
  buffer_load_dwordx4 a[0:3], v2, s[28:31], s92 offen offset:0 nt
  s_waitcnt vmcnt(12)
  buffer_load_dwordx4 a[4:7], v2, s[28:31], s92 offen offset:1024 nt
  s_waitcnt vmcnt(12)
  buffer_load_dwordx4 a[8:11], v2, s[28:31], s92 offen offset:2048 nt
  s_waitcnt vmcnt(12)
  buffer_load_dwordx4 a[12:15], v2, s[28:31], s92 offen offset:3072 nt
  v_sub_f32 v8, v238, v4
  v_exp_f32 v8, v8
  s_nop 0
  v_cvt_pk_bf16_f32 v8, v8, v8
  v_and_b32 v12, v8, v9
  v_and_b32 v13, v8, v10
  s_waitcnt vmcnt(8)
  s_nop 0
  v_mfma_f32_16x16x16_bf16 v[220:223], v[224:225], v[12:13], v[220:223]
  v_mfma_f32_16x16x16_bf16 v[52:55], a[16:17], v[12:13], v[52:55]
  v_mfma_f32_16x16x16_bf16 v[56:59], a[18:19], v[12:13], v[56:59]
  v_mfma_f32_16x16x16_bf16 v[60:63], a[20:21], v[12:13], v[60:63]
  v_mfma_f32_16x16x16_bf16 v[64:67], a[22:23], v[12:13], v[64:67]
  v_mfma_f32_16x16x16_bf16 v[68:71], a[24:25], v[12:13], v[68:71]
  v_mfma_f32_16x16x16_bf16 v[72:75], a[26:27], v[12:13], v[72:75]
  v_mfma_f32_16x16x16_bf16 v[76:79], a[28:29], v[12:13], v[76:79]
  v_mfma_f32_16x16x16_bf16 v[80:83], a[30:31], v[12:13], v[80:83]
  s_waitcnt vmcnt(12)
  buffer_load_dwordx4 a[16:19], v3, s[32:35], s92 offen offset:0 nt
  s_waitcnt vmcnt(12)
  buffer_load_dwordx4 a[20:23], v3, s[32:35], s92 offen offset:1024 nt
  s_waitcnt vmcnt(12)
  buffer_load_dwordx4 a[24:27], v3, s[32:35], s92 offen offset:2048 nt
  s_waitcnt vmcnt(12)
  buffer_load_dwordx4 a[28:31], v3, s[32:35], s92 offen offset:3072 nt
  s_branch L_dyn1
L_T2_3:
  v_add_u32 v231, s36, v230
  ds_read_b32 v236, v231 offset:4096
  v_add_u32 v231, s37, v230
  ds_read_b32 v237, v231 offset:4096
  v_add_u32 v231, s38, v230
  ds_read_b32 v238, v231 offset:4096
  s_waitcnt lgkmcnt(0)
  v_sub_f32 v8, v236, v4
  v_exp_f32 v8, v8
  s_nop 0
  v_cvt_pk_bf16_f32 v8, v8, v8
  v_and_b32 v12, v8, v9
  v_and_b32 v13, v8, v10
  s_waitcnt vmcnt(8)
  s_nop 0
  v_mfma_f32_16x16x16_bf16 v[220:223], v[224:225], v[12:13], v[220:223]
  v_mfma_f32_16x16x16_bf16 v[52:55], a[0:1], v[12:13], v[52:55]
  v_mfma_f32_16x16x16_bf16 v[56:59], a[2:3], v[12:13], v[56:59]
  v_mfma_f32_16x16x16_bf16 v[60:63], a[4:5], v[12:13], v[60:63]
  v_mfma_f32_16x16x16_bf16 v[64:67], a[6:7], v[12:13], v[64:67]
  v_mfma_f32_16x16x16_bf16 v[68:71], a[8:9], v[12:13], v[68:71]
  v_mfma_f32_16x16x16_bf16 v[72:75], a[10:11], v[12:13], v[72:75]
  v_mfma_f32_16x16x16_bf16 v[76:79], a[12:13], v[12:13], v[76:79]
  v_mfma_f32_16x16x16_bf16 v[80:83], a[14:15], v[12:13], v[80:83]
  s_waitcnt lgkmcnt(0)
  s_cmp_lt_u32 s84, s53
  s_cselect_b32 s30, 0x10000000, 0
  s_cselect_b32 s34, 0x10000000, 0
  s_cselect_b32 s89, s88, 1
  s_cselect_b32 s62, s84, 0
  s_cbranch_scc0 L_inv7
  s_mov_b32 s84, 1
  s_atomic_add s84, s[86:87], 0x0 glc
L_notk7:
  s_min_u32 s88, s88, s89
  s_add_u32 s62, s62, s52
  s_lshr_b32 s93, s62, 2
  s_and_b32 s94, s62, 3
  s_lshl_b32 s93, s93, 14
  s_lshl_b32 s94, s94, 12
  s_add_u32 s93, s93, s94
  s_add_u32 s92, s93, s74
L_tkd7:
  s_waitcnt vmcnt(12)
  buffer_load_dwordx4 a[0:3], v2, s[28:31], s92 offen offset:0 nt
  s_waitcnt vmcnt(12)
  buffer_load_dwordx4 a[4:7], v2, s[28:31], s92 offen offset:1024 nt
  s_waitcnt vmcnt(12)
  buffer_load_dwordx4 a[8:11], v2, s[28:31], s92 offen offset:2048 nt
  s_waitcnt vmcnt(12)
  buffer_load_dwordx4 a[12:15], v2, s[28:31], s92 offen offset:3072 nt
  v_sub_f32 v8, v237, v4
  v_exp_f32 v8, v8
  s_nop 0
  v_cvt_pk_bf16_f32 v8, v8, v8
  v_and_b32 v12, v8, v9
  v_and_b32 v13, v8, v10
  s_waitcnt vmcnt(8)
  s_nop 0
  v_mfma_f32_16x16x16_bf16 v[220:223], v[224:225], v[12:13], v[220:223]
  v_mfma_f32_16x16x16_bf16 v[52:55], a[16:17], v[12:13], v[52:55]
  v_mfma_f32_16x16x16_bf16 v[56:59], a[18:19], v[12:13], v[56:59]
  v_mfma_f32_16x16x16_bf16 v[60:63], a[20:21], v[12:13], v[60:63]
  v_mfma_f32_16x16x16_bf16 v[64:67], a[22:23], v[12:13], v[64:67]
  v_mfma_f32_16x16x16_bf16 v[68:71], a[24:25], v[12:13], v[68:71]
  v_mfma_f32_16x16x16_bf16 v[72:75], a[26:27], v[12:13], v[72:75]
  v_mfma_f32_16x16x16_bf16 v[76:79], a[28:29], v[12:13], v[76:79]
  v_mfma_f32_16x16x16_bf16 v[80:83], a[30:31], v[12:13], v[80:83]
  s_waitcnt vmcnt(12)
  buffer_load_dwordx4 a[16:19], v3, s[32:35], s92 offen offset:0 nt
  s_waitcnt vmcnt(12)
  buffer_load_dwordx4 a[20:23], v3, s[32:35], s92 offen offset:1024 nt
  s_waitcnt vmcnt(12)
  buffer_load_dwordx4 a[24:27], v3, s[32:35], s92 offen offset:2048 nt
  s_waitcnt vmcnt(12)
  buffer_load_dwordx4 a[28:31], v3, s[32:35], s92 offen offset:3072 nt
  v_sub_f32 v8, v238, v4
  v_exp_f32 v8, v8
  s_nop 0
  v_cvt_pk_bf16_f32 v8, v8, v8
  v_and_b32 v12, v8, v9
  v_and_b32 v13, v8, v10
  s_waitcnt vmcnt(8)
  s_nop 0
  v_mfma_f32_16x16x16_bf16 v[220:223], v[224:225], v[12:13], v[220:223]
  v_mfma_f32_16x16x16_bf16 v[52:55], a[32:33], v[12:13], v[52:55]
  v_mfma_f32_16x16x16_bf16 v[56:59], a[34:35], v[12:13], v[56:59]
  v_mfma_f32_16x16x16_bf16 v[60:63], a[36:37], v[12:13], v[60:63]
  v_mfma_f32_16x16x16_bf16 v[64:67], a[38:39], v[12:13], v[64:67]
  v_mfma_f32_16x16x16_bf16 v[68:71], a[40:41], v[12:13], v[68:71]
  v_mfma_f32_16x16x16_bf16 v[72:75], a[42:43], v[12:13], v[72:75]
  v_mfma_f32_16x16x16_bf16 v[76:79], a[44:45], v[12:13], v[76:79]
  v_mfma_f32_16x16x16_bf16 v[80:83], a[46:47], v[12:13], v[80:83]
  s_waitcnt lgkmcnt(0)
  s_cmp_lt_u32 s84, s53
  s_cselect_b32 s30, 0x10000000, 0
  s_cselect_b32 s34, 0x10000000, 0
  s_cselect_b32 s89, s88, 2
  s_cselect_b32 s62, s84, 0
  s_cbranch_scc0 L_inv8
  s_mov_b32 s84, 1
  s_atomic_add s84, s[86:87], 0x0 glc
L_notk8:
  s_min_u32 s88, s88, s89
  s_add_u32 s62, s62, s52
  s_lshr_b32 s93, s62, 2
  s_and_b32 s94, s62, 3
  s_lshl_b32 s93, s93, 14
  s_lshl_b32 s94, s94, 12
  s_add_u32 s93, s93, s94
  s_add_u32 s92, s93, s74
L_tkd8:
  s_waitcnt vmcnt(12)
  buffer_load_dwordx4 a[32:35], v2, s[28:31], s92 offen offset:0 nt
  s_waitcnt vmcnt(12)
  buffer_load_dwordx4 a[36:39], v2, s[28:31], s92 offen offset:1024 nt
  s_waitcnt vmcnt(12)
  buffer_load_dwordx4 a[40:43], v2, s[28:31], s92 offen offset:2048 nt
  s_waitcnt vmcnt(12)
  buffer_load_dwordx4 a[44:47], v2, s[28:31], s92 offen offset:3072 nt
  s_waitcnt vmcnt(12)
  buffer_load_dwordx4 a[48:51], v3, s[32:35], s92 offen offset:0 nt
  s_waitcnt vmcnt(12)
  buffer_load_dwordx4 a[52:55], v3, s[32:35], s92 offen offset:1024 nt
  s_waitcnt vmcnt(12)
  buffer_load_dwordx4 a[56:59], v3, s[32:35], s92 offen offset:2048 nt
  s_waitcnt vmcnt(12)
  buffer_load_dwordx4 a[60:63], v3, s[32:35], s92 offen offset:3072 nt
  s_branch L_dyn0
L_dyn0:
  s_sub_u32 s88, s88, 1
  s_cmp_eq_u32 s88, 0
  s_cbranch_scc1 L_done
  s_waitcnt vmcnt(12)
  v_mfma_f32_16x16x32_bf16 v[16:19], a[0:3], v[36:39], 0
  v_mfma_f32_16x16x32_bf16 v[16:19], a[4:7], v[40:43], v[16:19]
  v_mfma_f32_16x16x32_bf16 v[16:19], a[8:11], v[44:47], v[16:19]
  v_mfma_f32_16x16x32_bf16 v[16:19], a[12:15], v[48:51], v[16:19]
  s_waitcnt lgkmcnt(0)
  s_cmp_lt_u32 s84, s53
  s_cselect_b32 s30, 0x10000000, 0
  s_cselect_b32 s34, 0x10000000, 0
  s_cselect_b32 s89, s88, 2
  s_cselect_b32 s62, s84, 0
  s_cbranch_scc0 L_inv9
  s_mov_b32 s84, 1
  s_atomic_add s84, s[86:87], 0x0 glc
L_notk9:
  s_min_u32 s88, s88, s89
  s_add_u32 s62, s62, s52
  s_lshr_b32 s93, s62, 2
  s_and_b32 s94, s62, 3
  s_lshl_b32 s93, s93, 14
  s_lshl_b32 s94, s94, 12
  s_add_u32 s93, s93, s94
  s_add_u32 s92, s93, s74
L_tkd9:
  s_waitcnt vmcnt(12)
  buffer_load_dwordx4 a[0:3], v2, s[28:31], s92 offen offset:0 nt
  s_waitcnt vmcnt(12)
  buffer_load_dwordx4 a[4:7], v2, s[28:31], s92 offen offset:1024 nt
  s_waitcnt vmcnt(12)
  buffer_load_dwordx4 a[8:11], v2, s[28:31], s92 offen offset:2048 nt
  s_waitcnt vmcnt(12)
  buffer_load_dwordx4 a[12:15], v2, s[28:31], s92 offen offset:3072 nt
  v_mul_f32_dpp v24, v16, v6 quad_perm:[0,0,0,0] row_mask:0xf bank_mask:0xf
  v_mul_f32_dpp v25, v17, v6 quad_perm:[1,1,1,1] row_mask:0xf bank_mask:0xf
  v_mul_f32_dpp v26, v18, v6 quad_perm:[2,2,2,2] row_mask:0xf bank_mask:0xf
  v_mul_f32_dpp v27, v19, v6 quad_perm:[3,3,3,3] row_mask:0xf bank_mask:0xf
  v_add_f32 v24, v24, v25
  v_add_f32 v26, v26, v27
  v_add_f32 v7, v24, v26
  v_cmp_gt_f32 vcc, v7, v4
  s_cbranch_vccnz L_rescd0
L_backd0:
  v_sub_f32 v8, v7, v4
  v_exp_f32 v8, v8
  s_nop 0
  v_cvt_pk_bf16_f32 v8, v8, v8
  v_and_b32 v12, v8, v9
  v_and_b32 v13, v8, v10
  s_waitcnt vmcnt(12)
  s_nop 0
  v_mfma_f32_16x16x16_bf16 v[220:223], v[224:225], v[12:13], v[220:223]
  v_mfma_f32_16x16x16_bf16 v[52:55], a[16:17], v[12:13], v[52:55]
  v_mfma_f32_16x16x16_bf16 v[56:59], a[18:19], v[12:13], v[56:59]
  v_mfma_f32_16x16x16_bf16 v[60:63], a[20:21], v[12:13], v[60:63]
  v_mfma_f32_16x16x16_bf16 v[64:67], a[22:23], v[12:13], v[64:67]
  v_mfma_f32_16x16x16_bf16 v[68:71], a[24:25], v[12:13], v[68:71]
  v_mfma_f32_16x16x16_bf16 v[72:75], a[26:27], v[12:13], v[72:75]
  v_mfma_f32_16x16x16_bf16 v[76:79], a[28:29], v[12:13], v[76:79]
  v_mfma_f32_16x16x16_bf16 v[80:83], a[30:31], v[12:13], v[80:83]
  s_waitcnt vmcnt(12)
  buffer_load_dwordx4 a[16:19], v3, s[32:35], s92 offen offset:0 nt
  s_waitcnt vmcnt(12)
  buffer_load_dwordx4 a[20:23], v3, s[32:35], s92 offen offset:1024 nt
  s_waitcnt vmcnt(12)
  buffer_load_dwordx4 a[24:27], v3, s[32:35], s92 offen offset:2048 nt
  s_waitcnt vmcnt(12)
  buffer_load_dwordx4 a[28:31], v3, s[32:35], s92 offen offset:3072 nt
L_dyn1:
  s_sub_u32 s88, s88, 1
  s_cmp_eq_u32 s88, 0
  s_cbranch_scc1 L_done
  s_waitcnt vmcnt(12)
  v_mfma_f32_16x16x32_bf16 v[16:19], a[32:35], v[36:39], 0
  v_mfma_f32_16x16x32_bf16 v[16:19], a[36:39], v[40:43], v[16:19]
  v_mfma_f32_16x16x32_bf16 v[16:19], a[40:43], v[44:47], v[16:19]
  v_mfma_f32_16x16x32_bf16 v[16:19], a[44:47], v[48:51], v[16:19]
  s_waitcnt lgkmcnt(0)
  s_cmp_lt_u32 s84, s53
  s_cselect_b32 s30, 0x10000000, 0
  s_cselect_b32 s34, 0x10000000, 0
  s_cselect_b32 s89, s88, 2
  s_cselect_b32 s62, s84, 0
  s_cbranch_scc0 L_inv10
  s_mov_b32 s84, 1
  s_atomic_add s84, s[86:87], 0x0 glc
L_notk10:
  s_min_u32 s88, s88, s89
  s_add_u32 s62, s62, s52
  s_lshr_b32 s93, s62, 2
  s_and_b32 s94, s62, 3
  s_lshl_b32 s93, s93, 14
  s_lshl_b32 s94, s94, 12
  s_add_u32 s93, s93, s94
  s_add_u32 s92, s93, s74
L_tkd10:
  s_waitcnt vmcnt(12)
  buffer_load_dwordx4 a[32:35], v2, s[28:31], s92 offen offset:0 nt
  s_waitcnt vmcnt(12)
  buffer_load_dwordx4 a[36:39], v2, s[28:31], s92 offen offset:1024 nt
  s_waitcnt vmcnt(12)
  buffer_load_dwordx4 a[40:43], v2, s[28:31], s92 offen offset:2048 nt
  s_waitcnt vmcnt(12)
  buffer_load_dwordx4 a[44:47], v2, s[28:31], s92 offen offset:3072 nt
  v_mul_f32_dpp v24, v16, v6 quad_perm:[0,0,0,0] row_mask:0xf bank_mask:0xf
  v_mul_f32_dpp v25, v17, v6 quad_perm:[1,1,1,1] row_mask:0xf bank_mask:0xf
  v_mul_f32_dpp v26, v18, v6 quad_perm:[2,2,2,2] row_mask:0xf bank_mask:0xf
  v_mul_f32_dpp v27, v19, v6 quad_perm:[3,3,3,3] row_mask:0xf bank_mask:0xf
  v_add_f32 v24, v24, v25
  v_add_f32 v26, v26, v27
  v_add_f32 v7, v24, v26
  v_cmp_gt_f32 vcc, v7, v4
  s_cbranch_vccnz L_rescd1
L_backd1:
  v_sub_f32 v8, v7, v4
  v_exp_f32 v8, v8
  s_nop 0
  v_cvt_pk_bf16_f32 v8, v8, v8
  v_and_b32 v12, v8, v9
  v_and_b32 v13, v8, v10
  s_waitcnt vmcnt(12)
  s_nop 0
  v_mfma_f32_16x16x16_bf16 v[220:223], v[224:225], v[12:13], v[220:223]
  v_mfma_f32_16x16x16_bf16 v[52:55], a[48:49], v[12:13], v[52:55]
  v_mfma_f32_16x16x16_bf16 v[56:59], a[50:51], v[12:13], v[56:59]
  v_mfma_f32_16x16x16_bf16 v[60:63], a[52:53], v[12:13], v[60:63]
  v_mfma_f32_16x16x16_bf16 v[64:67], a[54:55], v[12:13], v[64:67]
  v_mfma_f32_16x16x16_bf16 v[68:71], a[56:57], v[12:13], v[68:71]
  v_mfma_f32_16x16x16_bf16 v[72:75], a[58:59], v[12:13], v[72:75]
  v_mfma_f32_16x16x16_bf16 v[76:79], a[60:61], v[12:13], v[76:79]
  v_mfma_f32_16x16x16_bf16 v[80:83], a[62:63], v[12:13], v[80:83]
  s_waitcnt vmcnt(12)
  buffer_load_dwordx4 a[48:51], v3, s[32:35], s92 offen offset:0 nt
  s_waitcnt vmcnt(12)
  buffer_load_dwordx4 a[52:55], v3, s[32:35], s92 offen offset:1024 nt
  s_waitcnt vmcnt(12)
  buffer_load_dwordx4 a[56:59], v3, s[32:35], s92 offen offset:2048 nt
  s_waitcnt vmcnt(12)
  buffer_load_dwordx4 a[60:63], v3, s[32:35], s92 offen offset:3072 nt
  s_branch L_dyn0
L_done:
  s_lshl_b32 s67, s3, 9
  v_lshl_add_u32 v7, v14, 2, v15
  v_lshl_add_u32 v7, v7, 5, s67
  s_lshl_b32 s67, s3, 3
  v_mov_b32 v8, s67
  s_nop 2
  v_add_f32_dpp v5, v220, v220 row_shl:4 row_mask:0xf bank_mask:0xf
  v_add_f32_dpp v52, v60, v52 row_shl:4 row_mask:0xf bank_mask:0xf
  v_add_f32_dpp v53, v61, v53 row_shl:4 row_mask:0xf bank_mask:0xf
  v_add_f32_dpp v54, v62, v54 row_shl:4 row_mask:0xf bank_mask:0xf
  v_add_f32_dpp v55, v63, v55 row_shl:4 row_mask:0xf bank_mask:0xf
  v_add_f32_dpp v56, v64, v56 row_shl:4 row_mask:0xf bank_mask:0xf
  v_add_f32_dpp v57, v65, v57 row_shl:4 row_mask:0xf bank_mask:0xf
  v_add_f32_dpp v58, v66, v58 row_shl:4 row_mask:0xf bank_mask:0xf
  v_add_f32_dpp v59, v67, v59 row_shl:4 row_mask:0xf bank_mask:0xf
  v_add_f32_dpp v52, v68, v52 row_shl:8 row_mask:0xf bank_mask:0xf
  v_add_f32_dpp v53, v69, v53 row_shl:8 row_mask:0xf bank_mask:0xf
  v_add_f32_dpp v54, v70, v54 row_shl:8 row_mask:0xf bank_mask:0xf
  v_add_f32_dpp v55, v71, v55 row_shl:8 row_mask:0xf bank_mask:0xf
  v_add_f32_dpp v56, v72, v56 row_shl:8 row_mask:0xf bank_mask:0xf
  v_add_f32_dpp v57, v73, v57 row_shl:8 row_mask:0xf bank_mask:0xf
  v_add_f32_dpp v58, v74, v58 row_shl:8 row_mask:0xf bank_mask:0xf
  v_add_f32_dpp v59, v75, v59 row_shl:8 row_mask:0xf bank_mask:0xf
  v_add_f32_dpp v5, v220, v5 row_shl:8 row_mask:0xf bank_mask:0xf
  v_add_f32_dpp v52, v76, v52 row_shl:12 row_mask:0xf bank_mask:0xf
  v_add_f32_dpp v53, v77, v53 row_shl:12 row_mask:0xf bank_mask:0xf
  v_add_f32_dpp v54, v78, v54 row_shl:12 row_mask:0xf bank_mask:0xf
  v_add_f32_dpp v55, v79, v55 row_shl:12 row_mask:0xf bank_mask:0xf
  v_add_f32_dpp v56, v80, v56 row_shl:12 row_mask:0xf bank_mask:0xf
  v_add_f32_dpp v57, v81, v57 row_shl:12 row_mask:0xf bank_mask:0xf
  v_add_f32_dpp v58, v82, v58 row_shl:12 row_mask:0xf bank_mask:0xf
  v_add_f32_dpp v59, v83, v59 row_shl:12 row_mask:0xf bank_mask:0xf
  v_add_f32_dpp v5, v220, v5 row_shl:12 row_mask:0xf bank_mask:0xf
  s_mov_b32 exec_lo, 0x000f000f
  s_mov_b32 exec_hi, 0x000f000f
  ds_write_b128 v7, v[52:55] offset:1024
  ds_write_b128 v7, v[56:59] offset:1040
  s_mov_b64 exec, 1
  ds_write_b64 v8, v[4:5] offset:3072
  ds_add_rtn_u32 v226, v1, v227 offset:268
  s_mov_b64 exec, -1
  s_waitcnt lgkmcnt(0)
  v_readfirstlane_b32 s66, v226
  s_nop 0
  s_cmp_eq_u32 s66, 5
  s_cbranch_scc1 L_tail0
L_fin:
  s_cmp_eq_u32 s3, 3
  s_cbranch_scc1 L_exit
  s_and_b32 s66, s60, 7
  s_cmp_eq_u32 s66, s61
  s_cbranch_scc0 L_exit
  s_lshr_b32 s71, s60, 3
  v_lshrrev_b32 v236, 3, v0
  v_and_b32 v237, 7, v0
  v_lshlrev_b32 v238, 4, v237
  v_lshl_add_u32 v236, v236, 9, v238
  v_lshlrev_b32 v238, 3, v237
  s_mov_b32 s67, 851968
  s_cmp_eq_u32 s3, 1
  s_cselect_b32 s67, 720896, s67
  s_lshl_b32 s66, s61, 14
  s_add_u32 s66, s66, s67
  s_lshl_b32 s67, s71, 7
  s_add_u32 s66, s66, s67
  s_add_u32 s67, s66, 4096
  s_add_u32 s68, s66, 8192
  s_add_u32 s69, s66, 12288
  s_cmp_eq_u32 s3, 1
  s_cbranch_scc1 L_finy
  s_mov_b32 s73, 400000
L_poll_z:
  buffer_load_dwordx4 v[172:175], v236, s[56:59], s66 offen sc1
  buffer_load_dwordx4 v[176:179], v236, s[56:59], s67 offen sc1
  buffer_load_dwordx4 v[180:183], v236, s[56:59], s68 offen sc1
  buffer_load_dwordx4 v[184:187], v236, s[56:59], s69 offen sc1
  s_sub_u32 s73, s73, 1
  s_waitcnt vmcnt(0)
  v_xor_b32 v244, s80, v173
  v_xor_b32 v245, s81, v175
  v_or_b32 v246, v244, v245
  v_xor_b32 v244, s80, v177
  v_xor_b32 v245, s81, v179
  v_or3_b32 v246, v244, v245, v246
  v_xor_b32 v244, s80, v181
  v_xor_b32 v245, s81, v183
  v_or3_b32 v246, v244, v245, v246
  v_xor_b32 v244, s80, v185
  v_xor_b32 v245, s81, v187
  v_or3_b32 v246, v244, v245, v246
  v_cmp_ne_u32 vcc, 0, v246
  s_cbranch_vccz L_polld_z
  s_cmp_lg_u32 s73, 0
  s_cbranch_scc1 L_poll_z
L_polld_z:
  v_add_f32 v172, v172, v176
  v_add_f32 v180, v180, v184
  v_add_f32 v174, v174, v178
  v_add_f32 v182, v182, v186
  v_add_f32 v16, v172, v180
  v_add_f32 v17, v174, v182
  s_nop 1
  v_add_f32_dpp v16, v16, v16 row_ror:8 row_mask:0xf bank_mask:0xf
  v_add_f32_dpp v17, v17, v17 row_ror:8 row_mask:0xf bank_mask:0xf
  v_mov_b32 v18, v16
  v_mov_b32 v19, v17
  s_nop 1
  v_permlane16_swap_b32 v16, v18
  v_permlane16_swap_b32 v17, v19
  v_add_f32 v16, v16, v18
  v_add_f32 v17, v17, v19
  v_mov_b32 v18, v16
  v_mov_b32 v19, v17
  s_nop 1
  v_permlane32_swap_b32 v16, v18
  v_permlane32_swap_b32 v17, v19
  v_add_f32 v16, v16, v18
  v_add_f32 v17, v17, v19
  v_cvt_pk_bf16_f32 v16, v16, v16
  v_cvt_pk_bf16_f32 v17, v17, v17
  v_and_b32 v16, 0xffff0000, v16
  v_and_b32 v17, 0xffff0000, v17
  v_mul_f32 v24, 0xbfb8aa3b, v16
  v_mul_f32 v25, 0xbfb8aa3b, v17
  v_exp_f32 v24, v24
  v_exp_f32 v25, v25
  s_nop 0
  v_add_f32 v24, 1.0, v24
  v_add_f32 v25, 1.0, v25
  v_rcp_f32 v24, v24
  v_rcp_f32 v25, v25
  s_nop 0
  v_mul_f32 v24, v16, v24
  v_mul_f32 v25, v17, v25
  v_cvt_pk_bf16_f32 v24, v24, v24
  v_cvt_pk_bf16_f32 v25, v25, v25
  v_and_b32 v24, 0xffff0000, v24
  v_and_b32 v25, 0xffff0000, v25
  ds_write_b64 v238, v[24:25] offset:768
  ds_write_b32 v1, v227 offset:292
  s_branch L_exit
L_finy:
  s_mov_b32 s76, s20
  s_mov_b32 s77, s21
  s_mov_b32 s78, 1024
  s_mov_b32 s79, 0x00020000
  s_lshl_b32 s70, s61, 7
  s_lshl_b32 s71, s71, 5
  s_add_u32 s70, s70, s71
  v_lshl_add_u32 v237, v237, 2, s70
  buffer_load_dword v239, v237, s[44:47], 0 offen
  buffer_load_dwordx4 v[84:87], v236, s[56:59], s66 offen sc1
  buffer_load_dwordx4 v[88:91], v236, s[56:59], s67 offen sc1
  buffer_load_dwordx4 v[92:95], v236, s[56:59], s68 offen sc1
  buffer_load_dwordx4 v[96:99], v236, s[56:59], s69 offen sc1
  s_mov_b32 s73, 400000
L_poll_y:
  s_waitcnt vmcnt(0)
  v_xor_b32 v244, s80, v85
  v_xor_b32 v245, s81, v87
  v_or_b32 v246, v244, v245
  v_xor_b32 v244, s80, v89
  v_xor_b32 v245, s81, v91
  v_or3_b32 v246, v244, v245, v246
  v_xor_b32 v244, s80, v93
  v_xor_b32 v245, s81, v95
  v_or3_b32 v246, v244, v245, v246
  v_xor_b32 v244, s80, v97
  v_xor_b32 v245, s81, v99
  v_or3_b32 v246, v244, v245, v246
  v_cmp_ne_u32 vcc, 0, v246
  s_cbranch_vccz L_goty0
  buffer_load_dwordx4 v[84:87], v236, s[56:59], s66 offen sc1
  buffer_load_dwordx4 v[88:91], v236, s[56:59], s67 offen sc1
  buffer_load_dwordx4 v[92:95], v236, s[56:59], s68 offen sc1
  buffer_load_dwordx4 v[96:99], v236, s[56:59], s69 offen sc1
  s_sub_u32 s73, s73, 1
  s_cmp_lg_u32 s73, 0
  s_cbranch_scc1 L_poll_y
  s_waitcnt vmcnt(0)
L_goty0:
  v_add_f32 v84, v84, v88
  v_add_f32 v92, v92, v96
  v_add_f32 v86, v86, v90
  v_add_f32 v94, v94, v98
  v_add_f32 v16, v84, v92
  v_add_f32 v17, v86, v94
L_ysum:
  ds_read_b32 v240, v1 offset:292
  ds_read_b64 v[24:25], v238 offset:768
  s_nop 1
  v_add_f32_dpp v16, v16, v16 row_ror:8 row_mask:0xf bank_mask:0xf
  v_add_f32_dpp v17, v17, v17 row_ror:8 row_mask:0xf bank_mask:0xf
  v_mov_b32 v18, v16
  v_mov_b32 v19, v17
  s_nop 1
  v_permlane16_swap_b32 v16, v18
  v_permlane16_swap_b32 v17, v19
  v_add_f32 v16, v16, v18
  v_add_f32 v17, v17, v19
  v_mov_b32 v18, v16
  v_mov_b32 v19, v17
  s_nop 1
  v_permlane32_swap_b32 v16, v18
  v_permlane32_swap_b32 v17, v19
  v_add_f32 v16, v16, v18
  v_add_f32 v17, v17, v19
  v_cvt_pk_bf16_f32 v16, v16, v16
  v_cvt_pk_bf16_f32 v17, v17, v17
  v_and_b32 v16, 0xffff0000, v16
  v_and_b32 v17, 0xffff0000, v17
  v_lshlrev_b32 v26, 16, v239
  v_and_b32 v27, 0xffff0000, v239
  s_waitcnt lgkmcnt(0)
  v_cmp_ne_u32 vcc, 0, v240
  s_cbranch_vccnz L_haveg
L_waitg:
  ds_read_b32 v240, v1 offset:292
  ds_read_b64 v[24:25], v238 offset:768
  s_waitcnt lgkmcnt(0)
  v_cmp_eq_u32 vcc, 0, v240
  s_cbranch_vccnz L_waitg
L_haveg:
  v_mul_f32 v16, v16, v24
  v_mul_f32 v17, v17, v25
  v_cvt_pk_bf16_f32 v16, v16, v16
  v_cvt_pk_bf16_f32 v17, v17, v17
  v_and_b32 v16, 0xffff0000, v16
  v_and_b32 v17, 0xffff0000, v17
  v_add_f32 v16, v26, v16
  v_add_f32 v17, v27, v17
  v_cvt_pk_bf16_f32 v16, v16, v17
  s_mov_b64 exec, 0xff
  buffer_store_dword v16, v237, s[76:79], 0 offen
  s_mov_b64 exec, -1
  s_branch L_exit
L_tail0:
  ds_read_b64 v[54:55], v1 offset:3080
  ds_read_b128 v[56:59], v1 offset:3088
  v_lshlrev_b32 v8, 3, v0
  ds_read_b64 v[62:63], v8 offset:1536
  ds_read_b64 v[64:65], v8 offset:2048
  ds_read_b64 v[66:67], v8 offset:2560
  v_mov_b32 v25, s80
  v_mov_b32 v27, s82
  v_mov_b32 v29, s80
  v_mov_b32 v31, s82
  s_lshl_b32 s66, s75, 10
  s_add_u32 s66, s66, 393216
  s_lshl_b32 s67, s75, 4
  s_add_u32 s67, s67, 655360
  s_add_u32 s68, s66, 1048576
  s_add_u32 s69, s67, 1048576
  s_waitcnt lgkmcnt(3)
  v_max3_f32 v28, v54, v56, v58
  v_sub_f32 v54, v54, v28
  v_sub_f32 v56, v56, v28
  v_sub_f32 v58, v58, v28
  v_exp_f32 v54, v54
  v_exp_f32 v56, v56
  v_exp_f32 v58, v58
  s_waitcnt lgkmcnt(0)
  v_mul_f32 v24, v54, v62
  v_mul_f32 v26, v54, v63
  v_fmac_f32 v24, v56, v64
  v_fmac_f32 v26, v56, v65
  v_fmac_f32 v24, v58, v66
  v_fmac_f32 v26, v58, v67
  buffer_store_dwordx4 v[24:27], v3, s[56:59], s68 offen
  v_mul_f32 v30, v54, v55
  v_fmac_f32 v30, v56, v57
  v_fmac_f32 v30, v58, v59
  s_mov_b64 exec, 1
  buffer_store_dwordx4 v[28:31], v1, s[56:59], s69 offen
  s_mov_b64 exec, -1
L_waitf3:
  ds_read_b32 v7, v1 offset:296
  s_waitcnt lgkmcnt(0)
  v_cmp_eq_u32 vcc, 0, v7
  s_cbranch_vccnz L_waitf3
  v_cmp_eq_u32 vcc, 1, v7
  s_cbranch_vccnz L_fin
  v_mov_b32 v27, s81
  v_mov_b32 v31, s81
  buffer_store_dwordx4 v[24:27], v3, s[56:59], s66 offen sc1
  s_mov_b64 exec, 1
  buffer_store_dwordx4 v[28:31], v1, s[56:59], s67 offen sc1
  s_mov_b64 exec, -1
  s_branch L_fin
L_tail0b:
  s_lshl_b32 s69, s60, 13
  s_add_u32 s69, s69, 393216
  s_add_u32 s70, s69, 4096
  s_lshl_b32 s68, s60, 7
  s_add_u32 s68, s68, 655360
  v_and_b32 v236, 7, v0
  v_lshlrev_b32 v236, 4, v236
  v_lshlrev_b32 v3, 4, v0
  v_lshlrev_b32 v237, 7, v14
  v_and_b32 v238, 1, v0
  v_lshl_add_u32 v237, v238, 6, v237
  v_bfe_u32 v238, v0, 1, 1
  v_lshl_add_u32 v237, v238, 4, v237
  v_bfe_u32 v238, v0, 2, 2
  v_lshl_add_u32 v237, v238, 2, v237
  v_add_u32 v239, 1048576, v3
  v_add_u32 v240, 1048576, v236
  s_mov_b32 s73, 80
  s_mov_b32 s72, 400000
L_poll_l:
  buffer_load_dwordx4 v[172:175], v239, s[56:59], s69 offen offset:0 nt
  buffer_load_dwordx4 v[176:179], v239, s[56:59], s69 offen offset:1024 nt
  buffer_load_dwordx4 v[180:183], v239, s[56:59], s69 offen offset:2048 nt
  buffer_load_dwordx4 v[184:187], v239, s[56:59], s69 offen offset:3072 nt
  buffer_load_dwordx4 v[188:191], v239, s[56:59], s70 offen offset:0 nt
  buffer_load_dwordx4 v[192:195], v239, s[56:59], s70 offen offset:1024 nt
  buffer_load_dwordx4 v[196:199], v239, s[56:59], s70 offen offset:2048 nt
  buffer_load_dwordx4 v[200:203], v239, s[56:59], s70 offen offset:3072 nt
  buffer_load_dwordx4 v[204:207], v240, s[56:59], s68 offen nt
  s_sub_u32 s73, s73, 1
  s_waitcnt vmcnt(0)
  v_xor_b32 v244, s80, v173
  v_xor_b32 v245, s82, v175
  v_or_b32 v246, v244, v245
  v_xor_b32 v244, s80, v177
  v_xor_b32 v245, s82, v179
  v_or3_b32 v246, v244, v245, v246
  v_xor_b32 v244, s80, v181
  v_xor_b32 v245, s82, v183
  v_or3_b32 v246, v244, v245, v246
  v_xor_b32 v244, s80, v185
  v_xor_b32 v245, s82, v187
  v_or3_b32 v246, v244, v245, v246
  v_xor_b32 v244, s80, v189
  v_xor_b32 v245, s82, v191
  v_or3_b32 v246, v244, v245, v246
  v_xor_b32 v244, s80, v193
  v_xor_b32 v245, s82, v195
  v_or3_b32 v246, v244, v245, v246
  v_xor_b32 v244, s80, v197
  v_xor_b32 v245, s82, v199
  v_or3_b32 v246, v244, v245, v246
  v_xor_b32 v244, s80, v201
  v_xor_b32 v245, s82, v203
  v_or3_b32 v246, v244, v245, v246
  v_xor_b32 v244, s80, v205
  v_xor_b32 v245, s82, v207
  v_or3_b32 v246, v244, v245, v246
  v_cmp_ne_u32 vcc, 0, v246
  s_cbranch_vccz L_gotl
  s_cmp_gt_i32 s73, 0
  s_cbranch_scc1 L_poll_l
  v_mov_b32 v241, 2
  ds_write_b32 v1, v241 offset:296
  buffer_load_dwordx4 v[172:175], v3, s[56:59], s69 offen offset:0 sc1
  buffer_load_dwordx4 v[176:179], v3, s[56:59], s69 offen offset:1024 sc1
  buffer_load_dwordx4 v[180:183], v3, s[56:59], s69 offen offset:2048 sc1
  buffer_load_dwordx4 v[184:187], v3, s[56:59], s69 offen offset:3072 sc1
  buffer_load_dwordx4 v[188:191], v3, s[56:59], s70 offen offset:0 sc1
  buffer_load_dwordx4 v[192:195], v3, s[56:59], s70 offen offset:1024 sc1
  buffer_load_dwordx4 v[196:199], v3, s[56:59], s70 offen offset:2048 sc1
  buffer_load_dwordx4 v[200:203], v3, s[56:59], s70 offen offset:3072 sc1
  buffer_load_dwordx4 v[204:207], v236, s[56:59], s68 offen sc1
  s_sub_u32 s72, s72, 1
  s_waitcnt vmcnt(0)
  v_xor_b32 v244, s80, v173
  v_xor_b32 v245, s81, v175
  v_or_b32 v246, v244, v245
  v_xor_b32 v244, s80, v177
  v_xor_b32 v245, s81, v179
  v_or3_b32 v246, v244, v245, v246
  v_xor_b32 v244, s80, v181
  v_xor_b32 v245, s81, v183
  v_or3_b32 v246, v244, v245, v246
  v_xor_b32 v244, s80, v185
  v_xor_b32 v245, s81, v187
  v_or3_b32 v246, v244, v245, v246
  v_xor_b32 v244, s80, v189
  v_xor_b32 v245, s81, v191
  v_or3_b32 v246, v244, v245, v246
  v_xor_b32 v244, s80, v193
  v_xor_b32 v245, s81, v195
  v_or3_b32 v246, v244, v245, v246
  v_xor_b32 v244, s80, v197
  v_xor_b32 v245, s81, v199
  v_or3_b32 v246, v244, v245, v246
  v_xor_b32 v244, s80, v201
  v_xor_b32 v245, s81, v203
  v_or3_b32 v246, v244, v245, v246
  v_xor_b32 v244, s80, v205
  v_xor_b32 v245, s81, v207
  v_or3_b32 v246, v244, v245, v246
  v_cmp_ne_u32 vcc, 0, v246
  s_cbranch_vccz L_polld_o
  s_cmp_lg_u32 s72, 0
  s_cbranch_scc1 L_poll_l
  s_branch L_polld_o
L_gotl:
  ds_write_b32 v1, v227 offset:296
L_polld_o:
  v_max_f32_dpp v7, v204, v204 quad_perm:[1,0,3,2] row_mask:0xf bank_mask:0xf
  s_nop 1
  v_max_f32_dpp v7, v7, v7 quad_perm:[2,3,0,1] row_mask:0xf bank_mask:0xf
  s_nop 1
  v_max_f32_dpp v7, v7, v7 row_half_mirror row_mask:0xf bank_mask:0xf
  v_sub_f32 v7, v204, v7
  v_exp_f32 v7, v7
  s_nop 0
  v_mul_f32 v8, v7, v206
  v_lshlrev_b32 v237, 3, v0
  v_mul_f32_dpp v24, v7, v172 row_newbcast:0 row_mask:0xf bank_mask:0xf
  v_mul_f32_dpp v25, v7, v174 row_newbcast:0 row_mask:0xf bank_mask:0xf
  v_add_f32_dpp v8, v8, v8 quad_perm:[1,0,3,2] row_mask:0xf bank_mask:0xf
  v_mul_f32_dpp v26, v7, v176 row_newbcast:1 row_mask:0xf bank_mask:0xf
  v_mul_f32_dpp v27, v7, v178 row_newbcast:1 row_mask:0xf bank_mask:0xf
  v_add_f32_dpp v8, v8, v8 quad_perm:[2,3,0,1] row_mask:0xf bank_mask:0xf
  v_fmac_f32_dpp v24, v7, v180 row_newbcast:2 row_mask:0xf bank_mask:0xf
  v_fmac_f32_dpp v25, v7, v182 row_newbcast:2 row_mask:0xf bank_mask:0xf
  v_add_f32_dpp v8, v8, v8 row_half_mirror row_mask:0xf bank_mask:0xf
  v_fmac_f32_dpp v26, v7, v184 row_newbcast:3 row_mask:0xf bank_mask:0xf
  v_fmac_f32_dpp v27, v7, v186 row_newbcast:3 row_mask:0xf bank_mask:0xf
  v_fmac_f32_dpp v24, v7, v188 row_newbcast:4 row_mask:0xf bank_mask:0xf
  v_fmac_f32_dpp v25, v7, v190 row_newbcast:4 row_mask:0xf bank_mask:0xf
  v_rcp_f32 v8, v8
  v_fmac_f32_dpp v26, v7, v192 row_newbcast:5 row_mask:0xf bank_mask:0xf
  v_fmac_f32_dpp v27, v7, v194 row_newbcast:5 row_mask:0xf bank_mask:0xf
  v_fmac_f32_dpp v24, v7, v196 row_newbcast:6 row_mask:0xf bank_mask:0xf
  v_fmac_f32_dpp v25, v7, v198 row_newbcast:6 row_mask:0xf bank_mask:0xf
  v_fmac_f32_dpp v26, v7, v200 row_newbcast:7 row_mask:0xf bank_mask:0xf
  v_fmac_f32_dpp v27, v7, v202 row_newbcast:7 row_mask:0xf bank_mask:0xf
  v_add_f32 v24, v24, v26
  v_add_f32 v25, v25, v27
  v_mul_f32 v24, v24, v8
  v_mul_f32 v25, v25, v8
  v_cvt_pk_bf16_f32 v24, v24, v24
  v_cvt_pk_bf16_f32 v25, v25, v25
  ds_write_b64 v237, v[24:25] offset:3328
  v_lshrrev_b32 v8, 3, v0
  v_lshlrev_b32 v8, 6, v8
  ds_read_b128 v[172:175], v8 offset:3328
  ds_read_b128 v[176:179], v8 offset:3344
  ds_read_b128 v[180:183], v8 offset:3360
  ds_read_b128 v[184:187], v8 offset:3376
  s_waitcnt lgkmcnt(0)
  v_and_b32 v24, v172, v20
  v_and_b32 v25, v172, v21
  v_and_b32 v26, v172, v22
  v_and_b32 v27, v172, v23
  v_and_b32 v28, v173, v20
  v_and_b32 v29, v173, v21
  v_and_b32 v30, v173, v22
  v_and_b32 v31, v173, v23
  v_mfma_f32_16x16x32_bf16 v[16:19], v[24:27], v[84:87], 0
  v_and_b32 v24, v174, v20
  v_and_b32 v25, v174, v21
  v_and_b32 v26, v174, v22
  v_and_b32 v27, v174, v23
  v_mfma_f32_16x16x32_bf16 v[16:19], v[28:31], v[88:91], v[16:19]
  v_and_b32 v28, v175, v20
  v_and_b32 v29, v175, v21
  v_and_b32 v30, v175, v22
  v_and_b32 v31, v175, v23
  v_mfma_f32_16x16x32_bf16 v[16:19], v[24:27], v[92:95], v[16:19]
  v_and_b32 v24, v176, v20
  v_and_b32 v25, v176, v21
  v_and_b32 v26, v176, v22
  v_and_b32 v27, v176, v23
  v_mfma_f32_16x16x32_bf16 v[16:19], v[28:31], v[96:99], v[16:19]
  v_and_b32 v28, v177, v20
  v_and_b32 v29, v177, v21
  v_and_b32 v30, v177, v22
  v_and_b32 v31, v177, v23
  v_mfma_f32_16x16x32_bf16 v[16:19], v[24:27], v[100:103], v[16:19]
  v_and_b32 v24, v178, v20
  v_and_b32 v25, v178, v21
  v_and_b32 v26, v178, v22
  v_and_b32 v27, v178, v23
  v_mfma_f32_16x16x32_bf16 v[16:19], v[28:31], v[104:107], v[16:19]
  v_and_b32 v28, v179, v20
  v_and_b32 v29, v179, v21
  v_and_b32 v30, v179, v22
  v_and_b32 v31, v179, v23
  v_mfma_f32_16x16x32_bf16 v[16:19], v[24:27], v[108:111], v[16:19]
  v_and_b32 v24, v180, v20
  v_and_b32 v25, v180, v21
  v_and_b32 v26, v180, v22
  v_and_b32 v27, v180, v23
  v_mfma_f32_16x16x32_bf16 v[16:19], v[28:31], v[112:115], v[16:19]
  v_and_b32 v28, v181, v20
  v_and_b32 v29, v181, v21
  v_and_b32 v30, v181, v22
  v_and_b32 v31, v181, v23
  v_mfma_f32_16x16x32_bf16 v[16:19], v[24:27], v[116:119], v[16:19]
  v_and_b32 v24, v182, v20
  v_and_b32 v25, v182, v21
  v_and_b32 v26, v182, v22
  v_and_b32 v27, v182, v23
  v_mfma_f32_16x16x32_bf16 v[16:19], v[28:31], v[120:123], v[16:19]
  v_and_b32 v28, v183, v20
  v_and_b32 v29, v183, v21
  v_and_b32 v30, v183, v22
  v_and_b32 v31, v183, v23
  v_mfma_f32_16x16x32_bf16 v[16:19], v[24:27], v[124:127], v[16:19]
  v_and_b32 v24, v184, v20
  v_and_b32 v25, v184, v21
  v_and_b32 v26, v184, v22
  v_and_b32 v27, v184, v23
  v_mfma_f32_16x16x32_bf16 v[16:19], v[28:31], v[128:131], v[16:19]
  v_and_b32 v28, v185, v20
  v_and_b32 v29, v185, v21
  v_and_b32 v30, v185, v22
  v_and_b32 v31, v185, v23
  v_mfma_f32_16x16x32_bf16 v[16:19], v[24:27], v[132:135], v[16:19]
  v_and_b32 v24, v186, v20
  v_and_b32 v25, v186, v21
  v_and_b32 v26, v186, v22
  v_and_b32 v27, v186, v23
  v_mfma_f32_16x16x32_bf16 v[16:19], v[28:31], v[136:139], v[16:19]
  v_and_b32 v28, v187, v20
  v_and_b32 v29, v187, v21
  v_and_b32 v30, v187, v22
  v_and_b32 v31, v187, v23
  v_mfma_f32_16x16x32_bf16 v[16:19], v[24:27], v[140:143], v[16:19]
  s_nop 0
  v_mfma_f32_16x16x32_bf16 v[16:19], v[28:31], v[144:147], v[16:19]
  s_lshl_b32 s66, s61, 14
  s_lshl_b32 s67, s60, 9
  s_add_u32 s66, s66, s67
  s_add_u32 s66, s66, 720896
  v_and_b32 v236, 0x1ff, v11
  v_mov_b32 v33, s80
  v_mov_b32 v35, s81
  s_nop 1
  v_permlane32_swap_b32 v16, v18
  v_permlane32_swap_b32 v17, v19
  s_nop 1
  v_add_f32_dpp v32, v18, v16 row_ror:8 row_mask:0xf bank_mask:0xf
  v_add_f32_dpp v34, v19, v17 row_ror:8 row_mask:0xf bank_mask:0xf
  s_mov_b32 exec_lo, 0x00ff00ff
  s_mov_b32 exec_hi, 0x00ff00ff
  buffer_store_dwordx4 v[32:35], v236, s[56:59], s66 offen sc1
  s_mov_b64 exec, -1
L_exit:
L_end:
  s_endpgm
L_inv1:
  ds_write_b32 v1, v227 offset:288
  s_branch L_notk1
L_inv2:
  ds_write_b32 v1, v227 offset:288
  s_branch L_notk2
L_inv3:
  ds_write_b32 v1, v227 offset:288
  s_branch L_notk3
L_inv4:
  ds_write_b32 v1, v227 offset:288
  s_branch L_notk4
L_inv5:
  ds_write_b32 v1, v227 offset:288
  s_branch L_notk5
L_inv6:
  ds_write_b32 v1, v227 offset:288
  s_branch L_notk6
L_inv7:
  ds_write_b32 v1, v227 offset:288
  s_branch L_notk7
L_inv8:
  ds_write_b32 v1, v227 offset:288
  s_branch L_notk8
L_inv9:
  ds_write_b32 v1, v227 offset:288
  s_branch L_notk9
L_inv10:
  ds_write_b32 v1, v227 offset:288
  s_branch L_notk10
L_rescd0:
  s_nop 0
  v_max_f32_dpp v8, v7, v7 row_ror:4 row_mask:0xf bank_mask:0xf
  s_nop 1
  v_max_f32_dpp v8, v8, v8 row_ror:8 row_mask:0xf bank_mask:0xf
  s_nop 0
  v_readlane_b32 s96, v8, 0
  v_readlane_b32 s97, v8, 16
  v_readlane_b32 s98, v8, 32
  v_readlane_b32 s99, v8, 48
  s_nop 1
  v_max_f32 v8, s96, v4
  v_max_f32 v8, s97, v8
  v_max_f32 v8, s98, v8
  v_max_f32 v8, s99, v8
  v_sub_f32 v24, v4, v8
  v_exp_f32 v24, v24
  v_mov_b32 v4, v8
  v_mul_f32 v220, v220, v24
  v_pk_mul_f32 v[52:53], v[52:53], v[24:25] op_sel_hi:[1,0]
  v_pk_mul_f32 v[54:55], v[54:55], v[24:25] op_sel_hi:[1,0]
  v_pk_mul_f32 v[56:57], v[56:57], v[24:25] op_sel_hi:[1,0]
  v_pk_mul_f32 v[58:59], v[58:59], v[24:25] op_sel_hi:[1,0]
  v_pk_mul_f32 v[60:61], v[60:61], v[24:25] op_sel_hi:[1,0]
  v_pk_mul_f32 v[62:63], v[62:63], v[24:25] op_sel_hi:[1,0]
  v_pk_mul_f32 v[64:65], v[64:65], v[24:25] op_sel_hi:[1,0]
  v_pk_mul_f32 v[66:67], v[66:67], v[24:25] op_sel_hi:[1,0]
  v_pk_mul_f32 v[68:69], v[68:69], v[24:25] op_sel_hi:[1,0]
  v_pk_mul_f32 v[70:71], v[70:71], v[24:25] op_sel_hi:[1,0]
  v_pk_mul_f32 v[72:73], v[72:73], v[24:25] op_sel_hi:[1,0]
  v_pk_mul_f32 v[74:75], v[74:75], v[24:25] op_sel_hi:[1,0]
  v_pk_mul_f32 v[76:77], v[76:77], v[24:25] op_sel_hi:[1,0]
  v_pk_mul_f32 v[78:79], v[78:79], v[24:25] op_sel_hi:[1,0]
  v_pk_mul_f32 v[80:81], v[80:81], v[24:25] op_sel_hi:[1,0]
  v_pk_mul_f32 v[82:83], v[82:83], v[24:25] op_sel_hi:[1,0]
  s_branch L_backd0
L_rescd1:
  s_nop 0
  v_max_f32_dpp v8, v7, v7 row_ror:4 row_mask:0xf bank_mask:0xf
  s_nop 1
  v_max_f32_dpp v8, v8, v8 row_ror:8 row_mask:0xf bank_mask:0xf
  s_nop 0
  v_readlane_b32 s96, v8, 0
  v_readlane_b32 s97, v8, 16
  v_readlane_b32 s98, v8, 32
  v_readlane_b32 s99, v8, 48
  s_nop 1
  v_max_f32 v8, s96, v4
  v_max_f32 v8, s97, v8
  v_max_f32 v8, s98, v8
  v_max_f32 v8, s99, v8
  v_sub_f32 v24, v4, v8
  v_exp_f32 v24, v24
  v_mov_b32 v4, v8
  v_mul_f32 v220, v220, v24
  v_pk_mul_f32 v[52:53], v[52:53], v[24:25] op_sel_hi:[1,0]
  v_pk_mul_f32 v[54:55], v[54:55], v[24:25] op_sel_hi:[1,0]
  v_pk_mul_f32 v[56:57], v[56:57], v[24:25] op_sel_hi:[1,0]
  v_pk_mul_f32 v[58:59], v[58:59], v[24:25] op_sel_hi:[1,0]
  v_pk_mul_f32 v[60:61], v[60:61], v[24:25] op_sel_hi:[1,0]
  v_pk_mul_f32 v[62:63], v[62:63], v[24:25] op_sel_hi:[1,0]
  v_pk_mul_f32 v[64:65], v[64:65], v[24:25] op_sel_hi:[1,0]
  v_pk_mul_f32 v[66:67], v[66:67], v[24:25] op_sel_hi:[1,0]
  v_pk_mul_f32 v[68:69], v[68:69], v[24:25] op_sel_hi:[1,0]
  v_pk_mul_f32 v[70:71], v[70:71], v[24:25] op_sel_hi:[1,0]
  v_pk_mul_f32 v[72:73], v[72:73], v[24:25] op_sel_hi:[1,0]
  v_pk_mul_f32 v[74:75], v[74:75], v[24:25] op_sel_hi:[1,0]
  v_pk_mul_f32 v[76:77], v[76:77], v[24:25] op_sel_hi:[1,0]
  v_pk_mul_f32 v[78:79], v[78:79], v[24:25] op_sel_hi:[1,0]
  v_pk_mul_f32 v[80:81], v[80:81], v[24:25] op_sel_hi:[1,0]
  v_pk_mul_f32 v[82:83], v[82:83], v[24:25] op_sel_hi:[1,0]
  s_branch L_backd1
.section .rodata,"a"
.p2align 6
.amdhsa_kernel recurrent_scan__gqa_block_cached__dense_activation_relu__decode_kernel
  .amdhsa_next_free_vgpr 512
  .amdhsa_next_free_sgpr 102
  .amdhsa_accum_offset 256
  .amdhsa_group_segment_fixed_size 0
  .amdhsa_kernarg_size 88
  .amdhsa_user_sgpr_count 2
  .amdhsa_user_sgpr_kernarg_segment_ptr 1
  .amdhsa_system_sgpr_workgroup_id_x 1
  .amdhsa_float_denorm_mode_32 3
.end_amdhsa_kernel
```
